```python
import torch

def _softmax(x, axis=-1):
    return torch.softmax(x, dim=axis)
def _gelu(x):
    return torch.nn.functional.gelu(x, approximate="tanh")
def _silu(x):
    return torch.nn.functional.silu(x)
def _sigmoid(x):
    return torch.sigmoid(x)
def _layernorm(x, axis=-1, eps=1e-5):
    m = x.mean(dim=axis, keepdim=True)
    v = x.var(dim=axis, keepdim=True, unbiased=False)
    return (x - m) / torch.sqrt(v + eps)
def _scatter_add(tgt, idx, src, axis=0):
    return tgt.clone().index_add_(axis, idx, src)
def _segment_sum(src, seg, n):
    out = torch.zeros((n,) + src.shape[1:], dtype=src.dtype)
    return out.index_add_(0, seg, src)
def _pad(x, pw):
    flat = tuple(v for pair in reversed(pw) for v in pair)
    return torch.nn.functional.pad(x, flat)

kernel_name = 'parallel_sum__sliding_local_dilated__glu_gated_glu__prompt'

def setup_inputs():

    _w = (lambda a: (lambda t: t.to(torch.bfloat16) if t.is_floating_point() else t)(torch.as_tensor(a)))
    def _A_setup():
        B, S, D = 1, 2048, 640
        return {
            "x": _w((lambda *s: torch.randn(*s, dtype=torch.bfloat16) * 0.05)(B, S, D)),
            "wqkv": _w((lambda *s: torch.randn(*s, dtype=torch.bfloat16) * 0.05)(D, 3 * D)),
            "wo": _w((lambda *s: torch.randn(*s, dtype=torch.bfloat16) * 0.05)(D, D)),
        }
    _A_in = _A_setup()

    def _B_setup():
        B, S, D, F = 1, 2048, 640, 1536
        return {
            "x": _w((lambda *s: torch.randn(*s, dtype=torch.bfloat16) * 0.05)(B, S, D)),
            "w_gate": _w((lambda *s: torch.randn(*s, dtype=torch.bfloat16) * 0.05)(D, F)),
            "w_up": _w((lambda *s: torch.randn(*s, dtype=torch.bfloat16) * 0.05)(D, F)),
            "w_down": _w((lambda *s: torch.randn(*s, dtype=torch.bfloat16) * 0.05)(F, D)),
        }
    _B_in = _B_setup()

    return {
        "A_x": _A_in["x"],
        "A_wqkv": _A_in["wqkv"],
        "A_wo": _A_in["wo"],
        "B_x": _B_in["x"],
        "B_w_gate": _B_in["w_gate"],
        "B_w_up": _B_in["w_up"],
        "B_w_down": _B_in["w_down"],
    }

def reference(A_x, A_wqkv, A_wo, B_x, B_w_gate, B_w_up, B_w_down):
    def _A_ref(x, wqkv, wo):
        B, S, D = x.shape
        H = 32; Dh = D // H
        W, dil = 8, 2
        qkv = (lambda x, *d: x.permute(*d))((x @ wqkv).reshape(B, S, 3, H, Dh), 2, 0, 3, 1, 4)
        q, k, v = qkv[0], qkv[1], qkv[2]
        scale = Dh ** -0.5
        pos = torch.arange(S)
        off = torch.arange(W) * dil
        idx = pos[:, None] - off[None, :]
        mask = idx >= 0
        idx_c = torch.where(mask, idx, 0).reshape(-1)
        kg = k[:, :, idx_c, :].reshape(B, H, S, W, Dh)
        vg = v[:, :, idx_c, :].reshape(B, H, S, W, Dh)
        logits = torch.einsum("bhsd,bhswd->bhsw", q, kg) * scale
        logits = torch.where(mask[None, None, :, :], logits, -1e9)
        attn = _softmax(logits, axis=-1)
        o = torch.einsum("bhsw,bhswd->bhsd", attn, vg)
        return (lambda x, *d: x.permute(*d))(o, 0, 2, 1, 3).reshape(B, S, D) @ wo

    def _B_ref(x, w_gate, w_up, w_down):
        g = torch.einsum("bsd,df->bsf", x, w_gate)
        u = torch.einsum("bsd,df->bsf", x, w_up)
        h = _sigmoid(g) * u
        return torch.einsum("bsf,fd->bsd", h, w_down)

    x = A_x
    xn = _layernorm(x, axis=-1)
    return x + _A_ref(xn, A_wqkv, A_wo) + _B_ref(xn, B_w_gate, B_w_up, B_w_down)
```

```asm
; @launch kernel=gemm1_kernel grid=(256,1,1) block=(512,1,1) lds=156672
; @launch kernel=gemm2_kernel grid=(256,1,1) block=(256,1,1) lds=86016
.amdgcn_target "amdgcn-amd-amdhsa--gfx950"
.text
.globl gemm1_kernel
.p2align 8
.type gemm1_kernel,@function
gemm1_kernel:
    s_cmp_ge_u32 s2, 256
    s_cbranch_scc1 k1_done
    s_load_dwordx16 s[16:31], s[0:1], 0
    s_load_dwordx4 s[32:35], s[0:1], 64
    s_memrealtime s[90:91]
    s_and_b32 s52, s2, 7
    s_lshr_b32 s53, s2, 3
    s_lshr_b32 s5, s52, 1
    s_lshl_b32 s5, s5, 2
    s_and_b32 s54, s53, 3
    s_add_u32 s5, s5, s54
    s_lshr_b32 s53, s53, 2
    s_and_b32 s6, s53, 1
    s_lshr_b32 s53, s53, 1
    s_and_b32 s4, s52, 1
    s_lshl_b32 s4, s4, 2
    s_add_u32 s4, s4, s53
    s_lshl_b32 s7, s5, 7
    v_lshrrev_b32 v1, 6, v0
    v_and_b32 v2, 63, v0
    v_readfirstlane_b32 s8, v1
    v_and_b32 v3, 15, v2
    v_lshrrev_b32 v4, 4, v2
    s_cmp_eq_u32 s6, 0
    s_cbranch_scc1 k1_qkv
    s_lshl_b32 s52, s8, 4
    s_add_u32 s52, s52, s7
    v_lshrrev_b32 v1, 3, v2
    v_add_u32 v5, s52, v1
    v_mul_u32_u24 v5, 1280, v5
    v_and_b32 v6, 7, v2
    v_xor_b32 v7, v6, v4
    v_lshl_add_u32 v100, v7, 4, v5
    v_or_b32 v7, 4, v4
    v_xor_b32 v7, v6, v7
    v_lshl_add_u32 v101, v7, 4, v5
    v_add_u32 v101, 9216, v101
    s_lshl_b32 s56, s8, 11
    s_and_b32 s52, s8, 3
    s_mul_i32 s53, s52, 192
    s_mul_i32 s54, s4, 384
    v_add_u32 v5, s53, v2
    v_mul_u32_u24 v6, 2731, v5
    v_lshrrev_b32 v6, 16, v6
    v_mul_u32_u24 v7, 24, v6
    v_sub_u32 v7, v5, v7
    v_and_b32 v1, 2, v6
    v_lshrrev_b32 v5, 1, v6
    v_and_b32 v5, 4, v5
    v_or_b32 v1, v1, v5
    v_xor_b32 v7, v7, v1
    v_mul_u32_u24 v6, 3072, v6
    v_lshl_add_u32 v6, v7, 4, v6
    v_add_u32 v102, s54, v6
    v_add_u32 v5, s53, v2
    v_add_u32 v5, 64, v5
    v_mul_u32_u24 v6, 2731, v5
    v_lshrrev_b32 v6, 16, v6
    v_mul_u32_u24 v7, 24, v6
    v_sub_u32 v7, v5, v7
    v_and_b32 v1, 2, v6
    v_lshrrev_b32 v5, 1, v6
    v_and_b32 v5, 4, v5
    v_or_b32 v1, v1, v5
    v_xor_b32 v7, v7, v1
    v_mul_u32_u24 v6, 3072, v6
    v_lshl_add_u32 v6, v7, 4, v6
    v_add_u32 v103, s54, v6
    v_subrev_u32 v103, 1024, v103
    v_add_u32 v5, s53, v2
    v_add_u32 v5, 128, v5
    v_mul_u32_u24 v6, 2731, v5
    v_lshrrev_b32 v6, 16, v6
    v_mul_u32_u24 v7, 24, v6
    v_sub_u32 v7, v5, v7
    v_and_b32 v1, 2, v6
    v_lshrrev_b32 v5, 1, v6
    v_and_b32 v5, 4, v5
    v_or_b32 v1, v1, v5
    v_xor_b32 v7, v7, v1
    v_mul_u32_u24 v6, 3072, v6
    v_lshl_add_u32 v6, v7, 4, v6
    v_add_u32 v104, s54, v6
    v_subrev_u32 v104, 2048, v104
    s_lshr_b32 s53, s8, 2
    s_mul_i32 s57, s53, 12288
    s_mul_i32 s53, s52, 3072
    s_add_u32 s57, s57, s53
    s_waitcnt lgkmcnt(0)
    s_sub_u32 s90, s90, 600
    s_mov_b32 s40, s16
    s_and_b32 s41, s17, 0xffff
    s_mov_b32 s42, 2621440
    s_mov_b32 s43, 0x20000
    s_mov_b32 s44, s34
    s_and_b32 s45, s35, 0xffff
    s_mov_b32 s46, 11698176
    s_mov_b32 s47, 0x20000
    s_cmp_lt_u32 s8, 4
    s_cselect_b32 s48, s24, s26
    s_cselect_b32 s49, s25, s27
    s_and_b32 s49, s49, 0xffff
    s_mov_b32 s50, 1966080
    s_mov_b32 s51, 0x20000
    s_lshr_b32 s3, s5, 2
    s_mul_i32 s3, s3, 5
    s_lshr_b32 s3, s3, 1
    s_lshl_b32 s13, s3, 7
    s_mul_i32 s14, s3, 196608
    s_mov_b32 s55, 0
    s_add_u32 m0, s55, s56
    s_nop 0
    buffer_load_dwordx4 v100, s[40:43], s13 offen offset:0 lds
    buffer_load_dwordx4 v101, s[40:43], s13 offen offset:1024 lds
    s_add_u32 s13, s13, 128
    s_cmp_eq_u32 s13, 1280
    s_cselect_b32 s13, 0, s13
    s_mov_b32 s55, 49152
    s_add_u32 m0, s55, s57
    s_nop 0
    buffer_load_dwordx4 v102, s[48:51], s14 offen offset:0 lds
    buffer_load_dwordx4 v103, s[48:51], s14 offen offset:1024 lds
    buffer_load_dwordx4 v104, s[48:51], s14 offen offset:2048 lds
    s_add_u32 s14, s14, 98304
    s_cmp_eq_u32 s14, 1966080
    s_cselect_b32 s14, 0, s14
    s_mov_b32 s55, 16384
    s_add_u32 m0, s55, s56
    s_nop 0
    buffer_load_dwordx4 v100, s[40:43], s13 offen offset:0 lds
    buffer_load_dwordx4 v101, s[40:43], s13 offen offset:1024 lds
    s_add_u32 s13, s13, 128
    s_cmp_eq_u32 s13, 1280
    s_cselect_b32 s13, 0, s13
    s_mov_b32 s55, 73728
    s_add_u32 m0, s55, s57
    s_nop 0
    buffer_load_dwordx4 v102, s[48:51], s14 offen offset:0 lds
    buffer_load_dwordx4 v103, s[48:51], s14 offen offset:1024 lds
    buffer_load_dwordx4 v104, s[48:51], s14 offen offset:2048 lds
    s_add_u32 s14, s14, 98304
    s_cmp_eq_u32 s14, 1966080
    s_cselect_b32 s14, 0, s14
    s_and_b32 s91, s2, 1
    s_lshl_b32 s91, s91, 3
    s_lshr_b32 s3, s2, 5
    s_add_u32 s91, s91, s3
    s_lshl_b32 s91, s91, 3
    s_add_u32 s91, s91, s7
    s_add_u32 s91, s91, s8
    v_mul_u32_u24 v13, 20, v2
    s_mul_i32 s3, s91, 1280
    v_add_u32 v27, s3, v13
    buffer_load_dwordx4 v[240:243], v27, s[40:43], 0 offen
    buffer_load_dword v244, v27, s[40:43], 0 offen offset:16
    s_add_u32 s92, s34, 11698176
    s_addc_u32 s93, s35, 0
    s_and_b32 s93, s93, 0xffff
    s_mov_b32 s94, 32768
    s_mov_b32 s95, 0x20000
    v_lshrrev_b32 v6, 1, v3
    v_xor_b32 v6, v6, v4
    v_lshlrev_b32 v6, 4, v6
    v_lshl_add_u32 v88, v3, 7, v6
    v_xor_b32 v89, 64, v88
    s_lshr_b32 s53, s8, 2
    s_lshl_b32 s53, s53, 13
    v_add_u32 v88, s53, v88
    v_add_u32 v89, s53, v89
    s_add_u32 s36, s53, 0
    s_add_u32 s37, s53, 2048
    s_add_u32 s38, s53, 4096
    s_add_u32 s39, s53, 6144
    v_lshrrev_b32 v5, 2, v3
    v_and_b32 v6, 3, v2
    v_lshl_add_u32 v7, v4, 3, v5
    v_mul_u32_u24 v7, 384, v7
    v_and_b32 v1, 1, v6
    v_lshl_add_u32 v7, v1, 3, v7
    v_and_b32 v5, 2, v5
    v_and_b32 v1, 1, v4
    v_lshl_or_b32 v5, v1, 2, v5
    v_lshrrev_b32 v6, 1, v6
    s_mul_i32 s53, s52, 6
    v_add_u32 v6, s53, v6
    v_add_u32 v1, 0, v6
    v_xor_b32 v1, v1, v5
    v_lshl_add_u32 v90, v1, 4, v7
    v_add_u32 v1, 2, v6
    v_xor_b32 v1, v1, v5
    v_lshl_add_u32 v91, v1, 4, v7
    v_add_u32 v1, 4, v6
    v_xor_b32 v1, v1, v5
    v_lshl_add_u32 v92, v1, 4, v7
    v_mov_b32 v248, 0x3f803f80
    v_mov_b32 v249, 0x3f803f80
    v_mov_b32 v250, 0x3f803f80
    v_mov_b32 v251, 0x3f803f80
    v_mov_b32 v128, 0
    v_mov_b32 v129, 0
    v_mov_b32 v130, 0
    v_mov_b32 v131, 0
    v_mov_b32 v132, 0
    v_mov_b32 v133, 0
    v_mov_b32 v134, 0
    v_mov_b32 v135, 0
    v_mov_b32 v136, 0
    v_mov_b32 v137, 0
    v_mov_b32 v138, 0
    v_mov_b32 v139, 0
    v_mov_b32 v140, 0
    v_mov_b32 v141, 0
    v_mov_b32 v142, 0
    v_mov_b32 v143, 0
    v_mov_b32 v144, 0
    v_mov_b32 v145, 0
    v_mov_b32 v146, 0
    v_mov_b32 v147, 0
    v_mov_b32 v148, 0
    v_mov_b32 v149, 0
    v_mov_b32 v150, 0
    v_mov_b32 v151, 0
    v_mov_b32 v152, 0
    v_mov_b32 v153, 0
    v_mov_b32 v154, 0
    v_mov_b32 v155, 0
    v_mov_b32 v156, 0
    v_mov_b32 v157, 0
    v_mov_b32 v158, 0
    v_mov_b32 v159, 0
    v_mov_b32 v160, 0
    v_mov_b32 v161, 0
    v_mov_b32 v162, 0
    v_mov_b32 v163, 0
    v_mov_b32 v164, 0
    v_mov_b32 v165, 0
    v_mov_b32 v166, 0
    v_mov_b32 v167, 0
    v_mov_b32 v168, 0
    v_mov_b32 v169, 0
    v_mov_b32 v170, 0
    v_mov_b32 v171, 0
    v_mov_b32 v172, 0
    v_mov_b32 v173, 0
    v_mov_b32 v174, 0
    v_mov_b32 v175, 0
    v_mov_b32 v176, 0
    v_mov_b32 v177, 0
    v_mov_b32 v178, 0
    v_mov_b32 v179, 0
    v_mov_b32 v180, 0
    v_mov_b32 v181, 0
    v_mov_b32 v182, 0
    v_mov_b32 v183, 0
    v_mov_b32 v184, 0
    v_mov_b32 v185, 0
    v_mov_b32 v186, 0
    v_mov_b32 v187, 0
    v_mov_b32 v188, 0
    v_mov_b32 v189, 0
    v_mov_b32 v190, 0
    v_mov_b32 v191, 0
    v_mov_b32 v192, 0
    v_mov_b32 v193, 0
    v_mov_b32 v194, 0
    v_mov_b32 v195, 0
    v_mov_b32 v196, 0
    v_mov_b32 v197, 0
    v_mov_b32 v198, 0
    v_mov_b32 v199, 0
    v_mov_b32 v200, 0
    v_mov_b32 v201, 0
    v_mov_b32 v202, 0
    v_mov_b32 v203, 0
    v_mov_b32 v204, 0
    v_mov_b32 v205, 0
    v_mov_b32 v206, 0
    v_mov_b32 v207, 0
    v_mov_b32 v208, 0
    v_mov_b32 v209, 0
    v_mov_b32 v210, 0
    v_mov_b32 v211, 0
    v_mov_b32 v212, 0
    v_mov_b32 v213, 0
    v_mov_b32 v214, 0
    v_mov_b32 v215, 0
    v_mov_b32 v216, 0
    v_mov_b32 v217, 0
    v_mov_b32 v218, 0
    v_mov_b32 v219, 0
    v_mov_b32 v220, 0
    v_mov_b32 v221, 0
    v_mov_b32 v222, 0
    v_mov_b32 v223, 0
    v_mov_b32 v224, 0
    v_mov_b32 v225, 0
    v_mov_b32 v226, 0
    v_mov_b32 v227, 0
    v_mov_b32 v228, 0
    v_mov_b32 v229, 0
    v_mov_b32 v230, 0
    v_mov_b32 v231, 0
    v_mov_b32 v232, 0
    v_mov_b32 v233, 0
    v_mov_b32 v234, 0
    v_mov_b32 v235, 0
    s_mov_b32 s55, 98304
    s_add_u32 m0, s55, s57
    s_nop 0
    buffer_load_dwordx4 v102, s[48:51], s14 offen offset:0 lds
    buffer_load_dwordx4 v103, s[48:51], s14 offen offset:1024 lds
    buffer_load_dwordx4 v104, s[48:51], s14 offen offset:2048 lds
    s_add_u32 s14, s14, 98304
    s_cmp_eq_u32 s14, 1966080
    s_cselect_b32 s14, 0, s14
    s_mov_b32 s55, 32768
    s_add_u32 m0, s55, s56
    s_nop 0
    buffer_load_dwordx4 v100, s[40:43], s13 offen offset:0 lds
    buffer_load_dwordx4 v101, s[40:43], s13 offen offset:1024 lds
    s_add_u32 s13, s13, 128
    s_cmp_eq_u32 s13, 1280
    s_cselect_b32 s13, 0, s13
    s_mov_b32 s55, 122880
    s_add_u32 m0, s55, s57
    s_nop 0
    buffer_load_dwordx4 v102, s[48:51], s14 offen offset:0 lds
    buffer_load_dwordx4 v103, s[48:51], s14 offen offset:1024 lds
    buffer_load_dwordx4 v104, s[48:51], s14 offen offset:2048 lds
    s_add_u32 s14, s14, 98304
    s_cmp_eq_u32 s14, 1966080
    s_cselect_b32 s14, 0, s14
    s_mov_b32 s9, 0
    s_mov_b32 s10, 16384
    s_mov_b32 s12, 49152
    s_mov_b32 s11, 73728
    s_mov_b32 s15, 0
    s_cmp_lt_u32 s8, 4
    s_cselect_b64 vcc, -1, 0
    s_waitcnt vmcnt(15)
    s_barrier
    v_add_u32 v93, s9, v88
    v_add_u32 v97, s12, v90
    v_add_u32 v98, s12, v91
    v_add_u32 v99, s12, v92
    ds_read_b128 v[8:11], v93 offset:0
    ds_read_b128 v[12:15], v93 offset:2048
    ds_read_b128 v[16:19], v93 offset:4096
    ds_read_b128 v[20:23], v93 offset:6144
    ds_read_b64_tr_b16 v[24:25], v97 offset:0
    ds_read_b64_tr_b16 v[26:27], v97 offset:1536
    ds_read_b64_tr_b16 v[28:29], v98 offset:0
    ds_read_b64_tr_b16 v[30:31], v98 offset:1536
    ds_read_b64_tr_b16 v[32:33], v99 offset:0
    ds_read_b64_tr_b16 v[34:35], v99 offset:1536
    ds_read_b64_tr_b16 v[36:37], v97 offset:12288
    ds_read_b64_tr_b16 v[38:39], v97 offset:13824
    ds_read_b64_tr_b16 v[40:41], v98 offset:12288
    ds_read_b64_tr_b16 v[42:43], v98 offset:13824
    ds_read_b64_tr_b16 v[44:45], v99 offset:12288
    ds_read_b64_tr_b16 v[46:47], v99 offset:13824
    s_waitcnt lgkmcnt(0)
glu_loop:
    s_waitcnt vmcnt(8)
    s_barrier
    v_add_u32 v93, s9, v89
    v_add_u32 v97, s11, v90
    v_add_u32 v98, s11, v91
    v_add_u32 v99, s11, v92
    v_mfma_f32_16x16x32_bf16 v[128:131], v[24:27], v[8:11], v[128:131]
    ds_read_b128 v[48:51], v93 offset:0
    v_mfma_f32_16x16x32_bf16 v[132:135], v[28:31], v[8:11], v[132:135]
    ds_read_b128 v[52:55], v93 offset:2048
    v_mfma_f32_16x16x32_bf16 v[136:139], v[32:35], v[8:11], v[136:139]
    ds_read_b128 v[56:59], v93 offset:4096
    v_mfma_f32_16x16x32_bf16 v[140:143], v[36:39], v[8:11], v[140:143]
    ds_read_b128 v[60:63], v93 offset:6144
    v_mfma_f32_16x16x32_bf16 v[144:147], v[40:43], v[8:11], v[144:147]
    s_add_u32 m0, s12, s57
    s_nop 0
    buffer_load_dwordx4 v102, s[48:51], s14 offen offset:0 lds
glu_sk_403:
    v_mfma_f32_16x16x32_bf16 v[148:151], v[44:47], v[8:11], v[148:151]
    ds_read_b64_tr_b16 v[64:65], v97 offset:0
    v_mfma_f32_16x16x32_bf16 v[152:155], v[24:27], v[12:15], v[152:155]
    ds_read_b64_tr_b16 v[66:67], v97 offset:1536
    v_mfma_f32_16x16x32_bf16 v[156:159], v[28:31], v[12:15], v[156:159]
    ds_read_b64_tr_b16 v[68:69], v98 offset:0
    v_mfma_f32_16x16x32_bf16 v[160:163], v[32:35], v[12:15], v[160:163]
    v_mfma_f32_16x16x32_bf16 v[164:167], v[36:39], v[12:15], v[164:167]
    ds_read_b64_tr_b16 v[70:71], v98 offset:1536
    v_mfma_f32_16x16x32_bf16 v[168:171], v[40:43], v[12:15], v[168:171]
    ds_read_b64_tr_b16 v[72:73], v99 offset:0
    v_mfma_f32_16x16x32_bf16 v[172:175], v[44:47], v[12:15], v[172:175]
    ds_read_b64_tr_b16 v[74:75], v99 offset:1536
    v_mfma_f32_16x16x32_bf16 v[176:179], v[24:27], v[16:19], v[176:179]
    s_add_u32 m0, s12, s57
    s_nop 0
    buffer_load_dwordx4 v103, s[48:51], s14 offen offset:1024 lds
glu_sk_421:
    v_mfma_f32_16x16x32_bf16 v[180:183], v[28:31], v[16:19], v[180:183]
    ds_read_b64_tr_b16 v[76:77], v97 offset:12288
    v_mfma_f32_16x16x32_bf16 v[184:187], v[32:35], v[16:19], v[184:187]
    ds_read_b64_tr_b16 v[78:79], v97 offset:13824
    v_mfma_f32_16x16x32_bf16 v[188:191], v[36:39], v[16:19], v[188:191]
    ds_read_b64_tr_b16 v[80:81], v98 offset:12288
    v_mfma_f32_16x16x32_bf16 v[192:195], v[40:43], v[16:19], v[192:195]
    v_mfma_f32_16x16x32_bf16 v[196:199], v[44:47], v[16:19], v[196:199]
    ds_read_b64_tr_b16 v[82:83], v98 offset:13824
    v_mfma_f32_16x16x32_bf16 v[200:203], v[24:27], v[20:23], v[200:203]
    ds_read_b64_tr_b16 v[84:85], v99 offset:12288
    v_mfma_f32_16x16x32_bf16 v[204:207], v[28:31], v[20:23], v[204:207]
    ds_read_b64_tr_b16 v[86:87], v99 offset:13824
    v_mfma_f32_16x16x32_bf16 v[208:211], v[32:35], v[20:23], v[208:211]
    s_add_u32 m0, s12, s57
    s_nop 0
    buffer_load_dwordx4 v104, s[48:51], s14 offen offset:2048 lds
    s_add_u32 s14, s14, 98304
    s_cmp_eq_u32 s14, 1966080
    s_cselect_b32 s14, 0, s14
glu_sk_439:
    v_mfma_f32_16x16x32_bf16 v[212:215], v[36:39], v[20:23], v[212:215]
    v_mfma_f32_16x16x32_bf16 v[216:219], v[40:43], v[20:23], v[216:219]
    v_mfma_f32_16x16x32_bf16 v[220:223], v[44:47], v[20:23], v[220:223]
    s_cbranch_vccz glu_cb_394_0
    v_mfma_f32_16x16x32_bf16 v[224:227], v[24:27], v[248:251], v[224:227]
    v_mfma_f32_16x16x32_bf16 v[228:231], v[28:31], v[248:251], v[228:231]
    v_mfma_f32_16x16x32_bf16 v[232:235], v[32:35], v[248:251], v[232:235]
    s_branch glu_cj_394_0
glu_cb_394_0:
    v_mfma_f32_16x16x32_bf16 v[224:227], v[36:39], v[248:251], v[224:227]
    v_mfma_f32_16x16x32_bf16 v[228:231], v[40:43], v[248:251], v[228:231]
    v_mfma_f32_16x16x32_bf16 v[232:235], v[44:47], v[248:251], v[232:235]
glu_cj_394_0:
    s_mov_b32 s12, s11
    s_add_u32 s11, s11, 24576
    s_cmp_ge_u32 s11, 147456
    s_cselect_b32 s11, 49152, s11
    s_waitcnt lgkmcnt(0)
    s_waitcnt vmcnt(8)
    s_barrier
    v_add_u32 v93, s10, v88
    v_add_u32 v97, s11, v90
    v_add_u32 v98, s11, v91
    v_add_u32 v99, s11, v92
    v_mfma_f32_16x16x32_bf16 v[128:131], v[64:67], v[48:51], v[128:131]
    ds_read_b128 v[8:11], v93 offset:0
    v_mfma_f32_16x16x32_bf16 v[132:135], v[68:71], v[48:51], v[132:135]
    ds_read_b128 v[12:15], v93 offset:2048
    v_mfma_f32_16x16x32_bf16 v[136:139], v[72:75], v[48:51], v[136:139]
    s_cmp_ge_u32 s15, 7
    s_cbranch_scc1 glu_sk_475
    s_add_u32 m0, s9, s56
    s_nop 0
    buffer_load_dwordx4 v100, s[40:43], s13 offen offset:0 lds
glu_sk_475:
    ds_read_b128 v[16:19], v93 offset:4096
    v_mfma_f32_16x16x32_bf16 v[140:143], v[76:79], v[48:51], v[140:143]
    ds_read_b128 v[20:23], v93 offset:6144
    v_mfma_f32_16x16x32_bf16 v[144:147], v[80:83], v[48:51], v[144:147]
    v_mfma_f32_16x16x32_bf16 v[148:151], v[84:87], v[48:51], v[148:151]
    ds_read_b64_tr_b16 v[24:25], v97 offset:0
    v_mfma_f32_16x16x32_bf16 v[152:155], v[64:67], v[52:55], v[152:155]
    ds_read_b64_tr_b16 v[26:27], v97 offset:1536
    v_mfma_f32_16x16x32_bf16 v[156:159], v[68:71], v[52:55], v[156:159]
    s_cmp_ge_u32 s15, 7
    s_cbranch_scc1 glu_sk_490
    s_add_u32 m0, s9, s56
    s_nop 0
    buffer_load_dwordx4 v101, s[40:43], s13 offen offset:1024 lds
    s_add_u32 s13, s13, 128
    s_cmp_eq_u32 s13, 1280
    s_cselect_b32 s13, 0, s13
glu_sk_490:
    ds_read_b64_tr_b16 v[28:29], v98 offset:0
    v_mfma_f32_16x16x32_bf16 v[160:163], v[72:75], v[52:55], v[160:163]
    v_mfma_f32_16x16x32_bf16 v[164:167], v[76:79], v[52:55], v[164:167]
    ds_read_b64_tr_b16 v[30:31], v98 offset:1536
    v_mfma_f32_16x16x32_bf16 v[168:171], v[80:83], v[52:55], v[168:171]
    ds_read_b64_tr_b16 v[32:33], v99 offset:0
    v_mfma_f32_16x16x32_bf16 v[172:175], v[84:87], v[52:55], v[172:175]
    ds_read_b64_tr_b16 v[34:35], v99 offset:1536
    v_mfma_f32_16x16x32_bf16 v[176:179], v[64:67], v[56:59], v[176:179]
    s_add_u32 m0, s12, s57
    s_nop 0
    buffer_load_dwordx4 v102, s[48:51], s14 offen offset:0 lds
glu_sk_508:
    v_mfma_f32_16x16x32_bf16 v[180:183], v[68:71], v[56:59], v[180:183]
    ds_read_b64_tr_b16 v[36:37], v97 offset:12288
    v_mfma_f32_16x16x32_bf16 v[184:187], v[72:75], v[56:59], v[184:187]
    ds_read_b64_tr_b16 v[38:39], v97 offset:13824
    v_mfma_f32_16x16x32_bf16 v[188:191], v[76:79], v[56:59], v[188:191]
    ds_read_b64_tr_b16 v[40:41], v98 offset:12288
    v_mfma_f32_16x16x32_bf16 v[192:195], v[80:83], v[56:59], v[192:195]
    s_add_u32 m0, s12, s57
    s_nop 0
    buffer_load_dwordx4 v103, s[48:51], s14 offen offset:1024 lds
glu_sk_519:
    v_mfma_f32_16x16x32_bf16 v[196:199], v[84:87], v[56:59], v[196:199]
    ds_read_b64_tr_b16 v[42:43], v98 offset:13824
    v_mfma_f32_16x16x32_bf16 v[200:203], v[64:67], v[60:63], v[200:203]
    ds_read_b64_tr_b16 v[44:45], v99 offset:12288
    v_mfma_f32_16x16x32_bf16 v[204:207], v[68:71], v[60:63], v[204:207]
    ds_read_b64_tr_b16 v[46:47], v99 offset:13824
    v_mfma_f32_16x16x32_bf16 v[208:211], v[72:75], v[60:63], v[208:211]
    v_mfma_f32_16x16x32_bf16 v[212:215], v[76:79], v[60:63], v[212:215]
    s_add_u32 m0, s12, s57
    s_nop 0
    buffer_load_dwordx4 v104, s[48:51], s14 offen offset:2048 lds
    s_add_u32 s14, s14, 98304
    s_cmp_eq_u32 s14, 1966080
    s_cselect_b32 s14, 0, s14
glu_sk_531:
    v_mfma_f32_16x16x32_bf16 v[216:219], v[80:83], v[60:63], v[216:219]
    v_mfma_f32_16x16x32_bf16 v[220:223], v[84:87], v[60:63], v[220:223]
    s_cbranch_vccz glu_cb_470_1
    v_mfma_f32_16x16x32_bf16 v[224:227], v[64:67], v[248:251], v[224:227]
    v_mfma_f32_16x16x32_bf16 v[228:231], v[68:71], v[248:251], v[228:231]
    v_mfma_f32_16x16x32_bf16 v[232:235], v[72:75], v[248:251], v[232:235]
    s_branch glu_cj_470_1
glu_cb_470_1:
    v_mfma_f32_16x16x32_bf16 v[224:227], v[76:79], v[248:251], v[224:227]
    v_mfma_f32_16x16x32_bf16 v[228:231], v[80:83], v[248:251], v[228:231]
    v_mfma_f32_16x16x32_bf16 v[232:235], v[84:87], v[248:251], v[232:235]
glu_cj_470_1:
    s_mov_b32 s12, s11
    s_add_u32 s11, s11, 24576
    s_cmp_ge_u32 s11, 147456
    s_cselect_b32 s11, 49152, s11
    s_mov_b32 s9, s10
    s_add_u32 s10, s10, 16384
    s_cmp_ge_u32 s10, 49152
    s_cselect_b32 s10, 0, s10
    s_waitcnt lgkmcnt(0)
    s_cmp_lg_u32 s15, 0
    s_cbranch_scc1 glu_nolate
    s_memrealtime s[96:97]
    v_mov_b32 v52, v240
    v_mov_b32 v53, v241
    v_mov_b32 v54, v242
    v_mov_b32 v55, v243
    v_mov_b32 v56, v244
    v_lshlrev_b32 v58, 16, v52
    v_and_b32 v59, 0xffff0000, v52
    v_lshlrev_b32 v60, 16, v53
    v_and_b32 v61, 0xffff0000, v53
    v_lshlrev_b32 v62, 16, v54
    v_and_b32 v63, 0xffff0000, v54
    v_lshlrev_b32 v64, 16, v55
    v_and_b32 v65, 0xffff0000, v55
    v_lshlrev_b32 v66, 16, v56
    v_and_b32 v67, 0xffff0000, v56
    v_add_f32 v68, v58, v59
    v_add_f32 v68, v68, v60
    v_add_f32 v68, v68, v61
    v_add_f32 v68, v68, v62
    v_add_f32 v68, v68, v63
    v_add_f32 v68, v68, v64
    v_add_f32 v68, v68, v65
    v_add_f32 v68, v68, v66
    v_add_f32 v68, v68, v67
    s_nop 1
    v_add_f32_dpp v68, v68, v68 quad_perm:[1,0,3,2] row_mask:0xf bank_mask:0xf
    s_nop 1
    v_add_f32_dpp v68, v68, v68 quad_perm:[2,3,0,1] row_mask:0xf bank_mask:0xf
    s_nop 1
    v_add_f32_dpp v68, v68, v68 row_half_mirror row_mask:0xf bank_mask:0xf
    s_nop 1
    v_add_f32_dpp v68, v68, v68 row_mirror row_mask:0xf bank_mask:0xf
    s_nop 1
    v_readlane_b32 s75, v68, 0
    v_readlane_b32 s76, v68, 16
    v_readlane_b32 s77, v68, 32
    v_readlane_b32 s78, v68, 48
    s_nop 1
    v_mov_b32 v68, s75
    v_add_f32 v68, s76, v68
    v_add_f32 v68, s77, v68
    v_add_f32 v68, s78, v68
    v_mul_f32 v68, 0x3acccccd, v68
    v_sub_f32 v70, v58, v68
    v_mul_f32 v69, v70, v70
    v_sub_f32 v70, v59, v68
    v_fmac_f32 v69, v70, v70
    v_sub_f32 v70, v60, v68
    v_fmac_f32 v69, v70, v70
    v_sub_f32 v70, v61, v68
    v_fmac_f32 v69, v70, v70
    v_sub_f32 v70, v62, v68
    v_fmac_f32 v69, v70, v70
    v_sub_f32 v70, v63, v68
    v_fmac_f32 v69, v70, v70
    v_sub_f32 v70, v64, v68
    v_fmac_f32 v69, v70, v70
    v_sub_f32 v70, v65, v68
    v_fmac_f32 v69, v70, v70
    v_sub_f32 v70, v66, v68
    v_fmac_f32 v69, v70, v70
    v_sub_f32 v70, v67, v68
    v_fmac_f32 v69, v70, v70
    s_nop 1
    v_add_f32_dpp v69, v69, v69 quad_perm:[1,0,3,2] row_mask:0xf bank_mask:0xf
    s_nop 1
    v_add_f32_dpp v69, v69, v69 quad_perm:[2,3,0,1] row_mask:0xf bank_mask:0xf
    s_nop 1
    v_add_f32_dpp v69, v69, v69 row_half_mirror row_mask:0xf bank_mask:0xf
    s_nop 1
    v_add_f32_dpp v69, v69, v69 row_mirror row_mask:0xf bank_mask:0xf
    s_nop 1
    v_readlane_b32 s75, v69, 0
    v_readlane_b32 s76, v69, 16
    v_readlane_b32 s77, v69, 32
    v_readlane_b32 s78, v69, 48
    s_nop 1
    v_mov_b32 v69, s75
    v_add_f32 v69, s76, v69
    v_add_f32 v69, s77, v69
    v_add_f32 v69, s78, v69
    v_mul_f32 v69, 0x3acccccd, v69
    v_cvt_pk_bf16_f32 v70, v68, v69
    v_lshlrev_b32 v68, 16, v70
    v_and_b32 v69, 0xffff0000, v70
    v_add_f32 v69, 0x3727c5ac, v69
    v_cvt_pk_bf16_f32 v69, v69, v69
    v_lshlrev_b32 v69, 16, v69
    v_sqrt_f32 v69, v69
    s_nop 0
    v_cvt_pk_bf16_f32 v69, v69, v69
    v_lshlrev_b32 v69, 16, v69
    v_rcp_f32 v69, v69
    s_nop 0
    s_lshl_b32 s3, s91, 4
    v_mov_b32 v70, v69
    v_mov_b32 v72, s3
    s_waitcnt lgkmcnt(0)
    v_mov_b32 v69, s96
    v_mov_b32 v71, s96
    s_mov_b64 exec, 1
    buffer_store_dwordx4 v[68:71], v72, s[92:95], 0 offen sc1
    s_mov_b64 exec, -1
    v_mov_b32 v52, 156416
    v_mov_b32 v53, 0
    ds_write_b32 v52, v53
    s_waitcnt lgkmcnt(0)
glu_nolate:
    s_add_u32 s15, s15, 1
    s_cmp_lt_u32 s15, 8
    s_cbranch_scc1 glu_loop
    s_waitcnt vmcnt(6)
    s_barrier
    v_add_u32 v93, s9, v89
    v_add_u32 v97, s11, v90
    v_add_u32 v98, s11, v91
    v_add_u32 v99, s11, v92
    v_mfma_f32_16x16x32_bf16 v[128:131], v[24:27], v[8:11], v[128:131]
    ds_read_b128 v[48:51], v93 offset:0
    v_mfma_f32_16x16x32_bf16 v[132:135], v[28:31], v[8:11], v[132:135]
    ds_read_b128 v[52:55], v93 offset:2048
    v_mfma_f32_16x16x32_bf16 v[136:139], v[32:35], v[8:11], v[136:139]
    ds_read_b128 v[56:59], v93 offset:4096
    v_mfma_f32_16x16x32_bf16 v[140:143], v[36:39], v[8:11], v[140:143]
    ds_read_b128 v[60:63], v93 offset:6144
    v_mfma_f32_16x16x32_bf16 v[144:147], v[40:43], v[8:11], v[144:147]
    v_mfma_f32_16x16x32_bf16 v[148:151], v[44:47], v[8:11], v[148:151]
    ds_read_b64_tr_b16 v[64:65], v97 offset:0
    v_mfma_f32_16x16x32_bf16 v[152:155], v[24:27], v[12:15], v[152:155]
    ds_read_b64_tr_b16 v[66:67], v97 offset:1536
    v_mfma_f32_16x16x32_bf16 v[156:159], v[28:31], v[12:15], v[156:159]
    ds_read_b64_tr_b16 v[68:69], v98 offset:0
    v_mfma_f32_16x16x32_bf16 v[160:163], v[32:35], v[12:15], v[160:163]
    v_mfma_f32_16x16x32_bf16 v[164:167], v[36:39], v[12:15], v[164:167]
    ds_read_b64_tr_b16 v[70:71], v98 offset:1536
    v_mfma_f32_16x16x32_bf16 v[168:171], v[40:43], v[12:15], v[168:171]
    ds_read_b64_tr_b16 v[72:73], v99 offset:0
    v_mfma_f32_16x16x32_bf16 v[172:175], v[44:47], v[12:15], v[172:175]
    ds_read_b64_tr_b16 v[74:75], v99 offset:1536
    v_mfma_f32_16x16x32_bf16 v[176:179], v[24:27], v[16:19], v[176:179]
    v_mfma_f32_16x16x32_bf16 v[180:183], v[28:31], v[16:19], v[180:183]
    ds_read_b64_tr_b16 v[76:77], v97 offset:12288
    v_mfma_f32_16x16x32_bf16 v[184:187], v[32:35], v[16:19], v[184:187]
    ds_read_b64_tr_b16 v[78:79], v97 offset:13824
    v_mfma_f32_16x16x32_bf16 v[188:191], v[36:39], v[16:19], v[188:191]
    ds_read_b64_tr_b16 v[80:81], v98 offset:12288
    v_mfma_f32_16x16x32_bf16 v[192:195], v[40:43], v[16:19], v[192:195]
    v_mfma_f32_16x16x32_bf16 v[196:199], v[44:47], v[16:19], v[196:199]
    ds_read_b64_tr_b16 v[82:83], v98 offset:13824
    v_mfma_f32_16x16x32_bf16 v[200:203], v[24:27], v[20:23], v[200:203]
    ds_read_b64_tr_b16 v[84:85], v99 offset:12288
    v_mfma_f32_16x16x32_bf16 v[204:207], v[28:31], v[20:23], v[204:207]
    ds_read_b64_tr_b16 v[86:87], v99 offset:13824
    v_mfma_f32_16x16x32_bf16 v[208:211], v[32:35], v[20:23], v[208:211]
    v_mfma_f32_16x16x32_bf16 v[212:215], v[36:39], v[20:23], v[212:215]
    v_mfma_f32_16x16x32_bf16 v[216:219], v[40:43], v[20:23], v[216:219]
    v_mfma_f32_16x16x32_bf16 v[220:223], v[44:47], v[20:23], v[220:223]
    s_cbranch_vccz glu_cb_679_0
    v_mfma_f32_16x16x32_bf16 v[224:227], v[24:27], v[248:251], v[224:227]
    v_mfma_f32_16x16x32_bf16 v[228:231], v[28:31], v[248:251], v[228:231]
    v_mfma_f32_16x16x32_bf16 v[232:235], v[32:35], v[248:251], v[232:235]
    s_branch glu_cj_679_0
glu_cb_679_0:
    v_mfma_f32_16x16x32_bf16 v[224:227], v[36:39], v[248:251], v[224:227]
    v_mfma_f32_16x16x32_bf16 v[228:231], v[40:43], v[248:251], v[228:231]
    v_mfma_f32_16x16x32_bf16 v[232:235], v[44:47], v[248:251], v[232:235]
glu_cj_679_0:
    s_mov_b32 s12, s11
    s_add_u32 s11, s11, 24576
    s_cmp_ge_u32 s11, 147456
    s_cselect_b32 s11, 49152, s11
    s_waitcnt lgkmcnt(0)
    s_waitcnt vmcnt(3)
    s_barrier
    s_sub_u32 s3, s7, 16
    v_add_u32 v245, s3, v0
    v_lshlrev_b32 v244, 4, v245
    buffer_load_dwordx4 v[240:243], v244, s[92:95], 0 offen sc1
    v_add_u32 v93, s10, v88
    v_add_u32 v97, s11, v90
    v_add_u32 v98, s11, v91
    v_add_u32 v99, s11, v92
    v_mfma_f32_16x16x32_bf16 v[128:131], v[64:67], v[48:51], v[128:131]
    ds_read_b128 v[8:11], v93 offset:0
    v_mfma_f32_16x16x32_bf16 v[132:135], v[68:71], v[48:51], v[132:135]
    ds_read_b128 v[12:15], v93 offset:2048
    v_mfma_f32_16x16x32_bf16 v[136:139], v[72:75], v[48:51], v[136:139]
    ds_read_b128 v[16:19], v93 offset:4096
    v_mfma_f32_16x16x32_bf16 v[140:143], v[76:79], v[48:51], v[140:143]
    ds_read_b128 v[20:23], v93 offset:6144
    v_mfma_f32_16x16x32_bf16 v[144:147], v[80:83], v[48:51], v[144:147]
    v_mfma_f32_16x16x32_bf16 v[148:151], v[84:87], v[48:51], v[148:151]
    ds_read_b64_tr_b16 v[24:25], v97 offset:0
    v_mfma_f32_16x16x32_bf16 v[152:155], v[64:67], v[52:55], v[152:155]
    ds_read_b64_tr_b16 v[26:27], v97 offset:1536
    v_mfma_f32_16x16x32_bf16 v[156:159], v[68:71], v[52:55], v[156:159]
    ds_read_b64_tr_b16 v[28:29], v98 offset:0
    v_mfma_f32_16x16x32_bf16 v[160:163], v[72:75], v[52:55], v[160:163]
    v_mfma_f32_16x16x32_bf16 v[164:167], v[76:79], v[52:55], v[164:167]
    ds_read_b64_tr_b16 v[30:31], v98 offset:1536
    v_mfma_f32_16x16x32_bf16 v[168:171], v[80:83], v[52:55], v[168:171]
    ds_read_b64_tr_b16 v[32:33], v99 offset:0
    v_mfma_f32_16x16x32_bf16 v[172:175], v[84:87], v[52:55], v[172:175]
    ds_read_b64_tr_b16 v[34:35], v99 offset:1536
    v_mfma_f32_16x16x32_bf16 v[176:179], v[64:67], v[56:59], v[176:179]
    v_mfma_f32_16x16x32_bf16 v[180:183], v[68:71], v[56:59], v[180:183]
    ds_read_b64_tr_b16 v[36:37], v97 offset:12288
    v_mfma_f32_16x16x32_bf16 v[184:187], v[72:75], v[56:59], v[184:187]
    ds_read_b64_tr_b16 v[38:39], v97 offset:13824
    v_mfma_f32_16x16x32_bf16 v[188:191], v[76:79], v[56:59], v[188:191]
    ds_read_b64_tr_b16 v[40:41], v98 offset:12288
    v_mfma_f32_16x16x32_bf16 v[192:195], v[80:83], v[56:59], v[192:195]
    v_mfma_f32_16x16x32_bf16 v[196:199], v[84:87], v[56:59], v[196:199]
    ds_read_b64_tr_b16 v[42:43], v98 offset:13824
    v_mfma_f32_16x16x32_bf16 v[200:203], v[64:67], v[60:63], v[200:203]
    ds_read_b64_tr_b16 v[44:45], v99 offset:12288
    v_mfma_f32_16x16x32_bf16 v[204:207], v[68:71], v[60:63], v[204:207]
    ds_read_b64_tr_b16 v[46:47], v99 offset:13824
    v_mfma_f32_16x16x32_bf16 v[208:211], v[72:75], v[60:63], v[208:211]
    v_mfma_f32_16x16x32_bf16 v[212:215], v[76:79], v[60:63], v[212:215]
    v_mfma_f32_16x16x32_bf16 v[216:219], v[80:83], v[60:63], v[216:219]
    v_mfma_f32_16x16x32_bf16 v[220:223], v[84:87], v[60:63], v[220:223]
    s_cbranch_vccz glu_cb_744_1
    v_mfma_f32_16x16x32_bf16 v[224:227], v[64:67], v[248:251], v[224:227]
    v_mfma_f32_16x16x32_bf16 v[228:231], v[68:71], v[248:251], v[228:231]
    v_mfma_f32_16x16x32_bf16 v[232:235], v[72:75], v[248:251], v[232:235]
    s_branch glu_cj_744_1
glu_cb_744_1:
    v_mfma_f32_16x16x32_bf16 v[224:227], v[76:79], v[248:251], v[224:227]
    v_mfma_f32_16x16x32_bf16 v[228:231], v[80:83], v[248:251], v[228:231]
    v_mfma_f32_16x16x32_bf16 v[232:235], v[84:87], v[248:251], v[232:235]
glu_cj_744_1:
    s_mov_b32 s12, s11
    s_add_u32 s11, s11, 24576
    s_cmp_ge_u32 s11, 147456
    s_cselect_b32 s11, 49152, s11
    s_mov_b32 s9, s10
    s_add_u32 s10, s10, 16384
    s_cmp_ge_u32 s10, 49152
    s_cselect_b32 s10, 0, s10
    s_waitcnt lgkmcnt(0)
    s_waitcnt vmcnt(0)
    s_barrier
    v_subrev_u32 v241, s90, v241
    v_subrev_u32 v243, s90, v243
    v_or_b32 v241, v241, v243
    v_lshrrev_b32 v241, 16, v241
    s_mov_b32 s3, 2048
    v_cmp_gt_u32_e64 s[76:77], s3, v245
    v_mov_b32 v243, v242
    v_mov_b32 v242, v240
    v_cndmask_b32_e64 v241, 0, v241, s[76:77]
    v_lshlrev_b32 v244, 3, v0
    v_add_u32 v244, 153600, v244
    s_movk_i32 s3, 144
    v_cmp_gt_u32_e64 s[76:77], s3, v0
    s_and_saveexec_b64 s[78:79], s[76:77]
    ds_write_b64 v244, v[242:243]
    v_cmp_ne_u32_e64 s[76:77], 0, v241
    s_and_b64 exec, exec, s[76:77]
    v_mov_b32 v244, 156416
    v_mov_b32 v245, 1
    ds_write_b32 v244, v245
    s_mov_b64 exec, s[78:79]
    v_add_u32 v93, s9, v89
    v_add_u32 v97, s11, v90
    v_add_u32 v98, s11, v91
    v_add_u32 v99, s11, v92
    v_mfma_f32_16x16x32_bf16 v[128:131], v[24:27], v[8:11], v[128:131]
    ds_read_b128 v[48:51], v93 offset:0
    v_mfma_f32_16x16x32_bf16 v[132:135], v[28:31], v[8:11], v[132:135]
    ds_read_b128 v[52:55], v93 offset:2048
    v_mfma_f32_16x16x32_bf16 v[136:139], v[32:35], v[8:11], v[136:139]
    ds_read_b128 v[56:59], v93 offset:4096
    v_mfma_f32_16x16x32_bf16 v[140:143], v[36:39], v[8:11], v[140:143]
    ds_read_b128 v[60:63], v93 offset:6144
    v_mfma_f32_16x16x32_bf16 v[144:147], v[40:43], v[8:11], v[144:147]
    v_mfma_f32_16x16x32_bf16 v[148:151], v[44:47], v[8:11], v[148:151]
    ds_read_b64_tr_b16 v[64:65], v97 offset:0
    v_mfma_f32_16x16x32_bf16 v[152:155], v[24:27], v[12:15], v[152:155]
    ds_read_b64_tr_b16 v[66:67], v97 offset:1536
    v_mfma_f32_16x16x32_bf16 v[156:159], v[28:31], v[12:15], v[156:159]
    ds_read_b64_tr_b16 v[68:69], v98 offset:0
    v_mfma_f32_16x16x32_bf16 v[160:163], v[32:35], v[12:15], v[160:163]
    v_mfma_f32_16x16x32_bf16 v[164:167], v[36:39], v[12:15], v[164:167]
    ds_read_b64_tr_b16 v[70:71], v98 offset:1536
    v_mfma_f32_16x16x32_bf16 v[168:171], v[40:43], v[12:15], v[168:171]
    ds_read_b64_tr_b16 v[72:73], v99 offset:0
    v_mfma_f32_16x16x32_bf16 v[172:175], v[44:47], v[12:15], v[172:175]
    ds_read_b64_tr_b16 v[74:75], v99 offset:1536
    v_mfma_f32_16x16x32_bf16 v[176:179], v[24:27], v[16:19], v[176:179]
    v_mfma_f32_16x16x32_bf16 v[180:183], v[28:31], v[16:19], v[180:183]
    ds_read_b64_tr_b16 v[76:77], v97 offset:12288
    v_mfma_f32_16x16x32_bf16 v[184:187], v[32:35], v[16:19], v[184:187]
    ds_read_b64_tr_b16 v[78:79], v97 offset:13824
    v_mfma_f32_16x16x32_bf16 v[188:191], v[36:39], v[16:19], v[188:191]
    ds_read_b64_tr_b16 v[80:81], v98 offset:12288
    v_mfma_f32_16x16x32_bf16 v[192:195], v[40:43], v[16:19], v[192:195]
    v_mfma_f32_16x16x32_bf16 v[196:199], v[44:47], v[16:19], v[196:199]
    ds_read_b64_tr_b16 v[82:83], v98 offset:13824
    v_mfma_f32_16x16x32_bf16 v[200:203], v[24:27], v[20:23], v[200:203]
    ds_read_b64_tr_b16 v[84:85], v99 offset:12288
    v_mfma_f32_16x16x32_bf16 v[204:207], v[28:31], v[20:23], v[204:207]
    ds_read_b64_tr_b16 v[86:87], v99 offset:13824
    v_mfma_f32_16x16x32_bf16 v[208:211], v[32:35], v[20:23], v[208:211]
    v_mfma_f32_16x16x32_bf16 v[212:215], v[36:39], v[20:23], v[212:215]
    v_mfma_f32_16x16x32_bf16 v[216:219], v[40:43], v[20:23], v[216:219]
    v_mfma_f32_16x16x32_bf16 v[220:223], v[44:47], v[20:23], v[220:223]
    s_cbranch_vccz glu_cb_830_0
    v_mfma_f32_16x16x32_bf16 v[224:227], v[24:27], v[248:251], v[224:227]
    v_mfma_f32_16x16x32_bf16 v[228:231], v[28:31], v[248:251], v[228:231]
    v_mfma_f32_16x16x32_bf16 v[232:235], v[32:35], v[248:251], v[232:235]
    s_branch glu_cj_830_0
glu_cb_830_0:
    v_mfma_f32_16x16x32_bf16 v[224:227], v[36:39], v[248:251], v[224:227]
    v_mfma_f32_16x16x32_bf16 v[228:231], v[40:43], v[248:251], v[228:231]
    v_mfma_f32_16x16x32_bf16 v[232:235], v[44:47], v[248:251], v[232:235]
glu_cj_830_0:
    s_mov_b32 s12, s11
    s_add_u32 s11, s11, 24576
    s_cmp_ge_u32 s11, 147456
    s_cselect_b32 s11, 49152, s11
    s_waitcnt lgkmcnt(0)
    s_barrier
    v_mfma_f32_16x16x32_bf16 v[128:131], v[64:67], v[48:51], v[128:131]
    v_mfma_f32_16x16x32_bf16 v[132:135], v[68:71], v[48:51], v[132:135]
    v_mfma_f32_16x16x32_bf16 v[136:139], v[72:75], v[48:51], v[136:139]
    v_mfma_f32_16x16x32_bf16 v[140:143], v[76:79], v[48:51], v[140:143]
    v_mfma_f32_16x16x32_bf16 v[144:147], v[80:83], v[48:51], v[144:147]
    v_mfma_f32_16x16x32_bf16 v[148:151], v[84:87], v[48:51], v[148:151]
    v_mfma_f32_16x16x32_bf16 v[152:155], v[64:67], v[52:55], v[152:155]
    v_mfma_f32_16x16x32_bf16 v[156:159], v[68:71], v[52:55], v[156:159]
    v_mfma_f32_16x16x32_bf16 v[160:163], v[72:75], v[52:55], v[160:163]
    v_mfma_f32_16x16x32_bf16 v[164:167], v[76:79], v[52:55], v[164:167]
    v_mfma_f32_16x16x32_bf16 v[168:171], v[80:83], v[52:55], v[168:171]
    v_mfma_f32_16x16x32_bf16 v[172:175], v[84:87], v[52:55], v[172:175]
    v_mfma_f32_16x16x32_bf16 v[176:179], v[64:67], v[56:59], v[176:179]
    v_mfma_f32_16x16x32_bf16 v[180:183], v[68:71], v[56:59], v[180:183]
    v_mfma_f32_16x16x32_bf16 v[184:187], v[72:75], v[56:59], v[184:187]
    v_mfma_f32_16x16x32_bf16 v[188:191], v[76:79], v[56:59], v[188:191]
    v_mfma_f32_16x16x32_bf16 v[192:195], v[80:83], v[56:59], v[192:195]
    v_mfma_f32_16x16x32_bf16 v[196:199], v[84:87], v[56:59], v[196:199]
    v_mfma_f32_16x16x32_bf16 v[200:203], v[64:67], v[60:63], v[200:203]
    v_mfma_f32_16x16x32_bf16 v[204:207], v[68:71], v[60:63], v[204:207]
    v_mfma_f32_16x16x32_bf16 v[208:211], v[72:75], v[60:63], v[208:211]
    v_mfma_f32_16x16x32_bf16 v[212:215], v[76:79], v[60:63], v[212:215]
    v_mfma_f32_16x16x32_bf16 v[216:219], v[80:83], v[60:63], v[216:219]
    v_mfma_f32_16x16x32_bf16 v[220:223], v[84:87], v[60:63], v[220:223]
    s_cbranch_vccz glu_cb_886_1
    v_mfma_f32_16x16x32_bf16 v[224:227], v[64:67], v[248:251], v[224:227]
    v_mfma_f32_16x16x32_bf16 v[228:231], v[68:71], v[248:251], v[228:231]
    v_mfma_f32_16x16x32_bf16 v[232:235], v[72:75], v[248:251], v[232:235]
    s_branch glu_cj_886_1
glu_cb_886_1:
    v_mfma_f32_16x16x32_bf16 v[224:227], v[76:79], v[248:251], v[224:227]
    v_mfma_f32_16x16x32_bf16 v[228:231], v[80:83], v[248:251], v[228:231]
    v_mfma_f32_16x16x32_bf16 v[232:235], v[84:87], v[248:251], v[232:235]
glu_cj_886_1:
    s_waitcnt vmcnt(0)
    s_barrier
    s_lshr_b32 s53, s8, 2
    s_mul_i32 s53, s53, 768
    s_mul_i32 s54, s52, 192
    s_add_u32 s54, s54, 154880
    v_lshlrev_b32 v6, 4, v4
    v_add_u32 v6, s54, v6
    v_add_u32 v7, s53, v6
    s_nop 4
    s_mov_b32 exec_lo, 0x00010001
    s_mov_b32 exec_hi, 0x00010001
    ds_write_b128 v7, v[224:227] offset:0
    ds_write_b128 v7, v[228:231] offset:64
    ds_write_b128 v7, v[232:235] offset:128
    s_mov_b64 exec, -1
    v_mov_b32 v30, v6
    s_mov_b32 s59, 0
    s_sub_u32 s3, s7, 16
    v_add_u32 v5, s3, v0
    v_lshlrev_b32 v6, 4, v5
    v_lshlrev_b32 v7, 3, v0
    v_add_u32 v7, 153600, v7
    v_mov_b32 v13, 156416
    s_branch glu_g_check
glu_g_retry:
    buffer_load_dwordx4 v[8:11], v6, s[92:95], 0 offen sc1
    v_mov_b32 v14, 0
    ds_write_b32 v13, v14
    s_waitcnt vmcnt(0) lgkmcnt(0)
    s_barrier
    v_subrev_u32 v9, s90, v9
    v_subrev_u32 v11, s90, v11
    v_or_b32 v9, v9, v11
    v_lshrrev_b32 v9, 16, v9
    v_cmp_gt_u32 vcc, 144, v0
    s_nop 1
    v_cndmask_b32 v9, 0, v9, vcc
    v_cmp_gt_u32 vcc, 2048, v5
    s_nop 1
    v_cndmask_b32 v9, 0, v9, vcc
    v_mov_b32 v11, v10
    v_mov_b32 v10, v8
    v_cmp_gt_u32 vcc, 144, v0
    s_and_saveexec_b64 s[76:77], vcc
    ds_write_b64 v7, v[10:11]
    s_mov_b64 exec, s[76:77]
    v_cmp_ne_u32 vcc, 0, v9
    s_and_saveexec_b64 s[76:77], vcc
    v_mov_b32 v14, 1
    ds_write_b32 v13, v14
    s_mov_b64 exec, s[76:77]
glu_g_check:
    s_waitcnt lgkmcnt(0)
    s_barrier
    ds_read_b32 v14, v13
    s_waitcnt lgkmcnt(0)
    v_readfirstlane_b32 s3, v14
    s_nop 3
    s_cmp_eq_u32 s3, 0
    s_cbranch_scc1 glu_g_done
    s_barrier
    s_add_u32 s59, s59, 1
    s_cmp_lt_u32 s59, 300
    s_cbranch_scc1 glu_g_retry
    s_mov_b32 s91, s8
    v_mul_u32_u24 v13, 20, v2
glu_g_fb:
    s_add_u32 s3, s91, s7
    s_sub_u32 s3, s3, 16
    s_mul_i32 s3, s3, 1280
    v_add_u32 v27, s3, v13
    buffer_load_dwordx4 v[8:11], v27, s[40:43], 0 offen
    buffer_load_dword v12, v27, s[40:43], 0 offen offset:16
    s_waitcnt vmcnt(0)
    v_lshlrev_b32 v14, 16, v8
    v_and_b32 v15, 0xffff0000, v8
    v_lshlrev_b32 v16, 16, v9
    v_and_b32 v17, 0xffff0000, v9
    v_lshlrev_b32 v18, 16, v10
    v_and_b32 v19, 0xffff0000, v10
    v_lshlrev_b32 v20, 16, v11
    v_and_b32 v21, 0xffff0000, v11
    v_lshlrev_b32 v22, 16, v12
    v_and_b32 v23, 0xffff0000, v12
    v_add_f32 v24, v14, v15
    v_add_f32 v24, v24, v16
    v_add_f32 v24, v24, v17
    v_add_f32 v24, v24, v18
    v_add_f32 v24, v24, v19
    v_add_f32 v24, v24, v20
    v_add_f32 v24, v24, v21
    v_add_f32 v24, v24, v22
    v_add_f32 v24, v24, v23
    s_nop 1
    v_add_f32_dpp v24, v24, v24 quad_perm:[1,0,3,2] row_mask:0xf bank_mask:0xf
    s_nop 1
    v_add_f32_dpp v24, v24, v24 quad_perm:[2,3,0,1] row_mask:0xf bank_mask:0xf
    s_nop 1
    v_add_f32_dpp v24, v24, v24 row_half_mirror row_mask:0xf bank_mask:0xf
    s_nop 1
    v_add_f32_dpp v24, v24, v24 row_mirror row_mask:0xf bank_mask:0xf
    s_nop 1
    v_readlane_b32 s75, v24, 0
    v_readlane_b32 s76, v24, 16
    v_readlane_b32 s77, v24, 32
    v_readlane_b32 s78, v24, 48
    s_nop 1
    v_mov_b32 v24, s75
    v_add_f32 v24, s76, v24
    v_add_f32 v24, s77, v24
    v_add_f32 v24, s78, v24
    v_mul_f32 v24, 0x3acccccd, v24
    v_sub_f32 v26, v14, v24
    v_mul_f32 v25, v26, v26
    v_sub_f32 v26, v15, v24
    v_fmac_f32 v25, v26, v26
    v_sub_f32 v26, v16, v24
    v_fmac_f32 v25, v26, v26
    v_sub_f32 v26, v17, v24
    v_fmac_f32 v25, v26, v26
    v_sub_f32 v26, v18, v24
    v_fmac_f32 v25, v26, v26
    v_sub_f32 v26, v19, v24
    v_fmac_f32 v25, v26, v26
    v_sub_f32 v26, v20, v24
    v_fmac_f32 v25, v26, v26
    v_sub_f32 v26, v21, v24
    v_fmac_f32 v25, v26, v26
    v_sub_f32 v26, v22, v24
    v_fmac_f32 v25, v26, v26
    v_sub_f32 v26, v23, v24
    v_fmac_f32 v25, v26, v26
    s_nop 1
    v_add_f32_dpp v25, v25, v25 quad_perm:[1,0,3,2] row_mask:0xf bank_mask:0xf
    s_nop 1
    v_add_f32_dpp v25, v25, v25 quad_perm:[2,3,0,1] row_mask:0xf bank_mask:0xf
    s_nop 1
    v_add_f32_dpp v25, v25, v25 row_half_mirror row_mask:0xf bank_mask:0xf
    s_nop 1
    v_add_f32_dpp v25, v25, v25 row_mirror row_mask:0xf bank_mask:0xf
    s_nop 1
    v_readlane_b32 s75, v25, 0
    v_readlane_b32 s76, v25, 16
    v_readlane_b32 s77, v25, 32
    v_readlane_b32 s78, v25, 48
    s_nop 1
    v_mov_b32 v25, s75
    v_add_f32 v25, s76, v25
    v_add_f32 v25, s77, v25
    v_add_f32 v25, s78, v25
    v_mul_f32 v25, 0x3acccccd, v25
    v_cvt_pk_bf16_f32 v26, v24, v25
    v_lshlrev_b32 v24, 16, v26
    v_and_b32 v25, 0xffff0000, v26
    v_add_f32 v25, 0x3727c5ac, v25
    v_cvt_pk_bf16_f32 v25, v25, v25
    v_lshlrev_b32 v25, 16, v25
    v_sqrt_f32 v25, v25
    s_nop 0
    v_cvt_pk_bf16_f32 v25, v25, v25
    v_lshlrev_b32 v25, 16, v25
    v_rcp_f32 v25, v25
    s_nop 0
    s_lshl_b32 s3, s91, 3
    s_add_u32 s3, s3, 153600
    v_mov_b32 v26, s3
    ds_write_b64 v26, v[24:25]
    s_add_u32 s91, s91, 8
    s_cmp_lt_u32 s91, 144
    s_cbranch_scc1 glu_g_fb
    s_waitcnt lgkmcnt(0)
    s_barrier
glu_g_done:
    v_mov_b32 v6, v30
    v_lshlrev_b32 v5, 3, v3
    v_add_u32 v5, 153728, v5
    s_lshr_b32 s53, s36, 4
    v_add_u32 v7, s53, v5
    ds_read_b64 v[8:9], v7
    s_lshr_b32 s53, s37, 4
    v_add_u32 v7, s53, v5
    ds_read_b64 v[10:11], v7
    s_lshr_b32 s53, s38, 4
    v_add_u32 v7, s53, v5
    ds_read_b64 v[12:13], v7
    s_lshr_b32 s53, s39, 4
    v_add_u32 v7, s53, v5
    ds_read_b64 v[14:15], v7
    ds_read_b128 v[32:35], v6 offset:0
    ds_read_b128 v[44:47], v6 offset:768
    ds_read_b128 v[36:39], v6 offset:64
    ds_read_b128 v[48:51], v6 offset:832
    ds_read_b128 v[40:43], v6 offset:128
    ds_read_b128 v[52:55], v6 offset:896
    s_mov_b32 s73, 0xbfb8aa3b
    s_waitcnt lgkmcnt(0)
    v_xor_b32 v56, 0x80000000, v8
    v_mov_b32 v57, v9
    v_mul_f32 v58, s73, v9
    v_xor_b32 v60, 0x80000000, v10
    v_mov_b32 v61, v11
    v_mul_f32 v62, s73, v11
    v_xor_b32 v64, 0x80000000, v12
    v_mov_b32 v65, v13
    v_mul_f32 v66, s73, v13
    v_xor_b32 v68, 0x80000000, v14
    v_mov_b32 v69, v15
    v_mul_f32 v70, s73, v15
    v_mov_b32 v72, 1.0
    v_mov_b32 v73, 1.0
    s_mul_i32 s53, s5, 557056
    s_mul_i32 s54, s4, 12
    s_mul_i32 s55, s52, 3
    s_add_u32 s54, s54, s55
    s_add_u32 s54, s54, 40
    s_lshl_b32 s54, s54, 9
    s_add_u32 s53, s53, s54
    v_lshrrev_b32 v5, 1, v4
    v_lshlrev_b32 v5, 8, v5
    v_lshl_add_u32 v5, v3, 4, v5
    v_and_b32 v6, 1, v4
    v_lshl_add_u32 v5, v6, 3, v5
    v_add_u32 v5, s53, v5
    s_mul_i32 s54, s36, 34
    v_pk_fma_f32 v[128:129], v[32:33], v[56:57], v[128:129] op_sel_hi:[1,0,1]
    v_pk_fma_f32 v[140:141], v[44:45], v[56:57], v[140:141] op_sel_hi:[1,0,1]
    v_pk_fma_f32 v[130:131], v[34:35], v[56:57], v[130:131] op_sel_hi:[1,0,1]
    v_pk_fma_f32 v[142:143], v[46:47], v[56:57], v[142:143] op_sel_hi:[1,0,1]
    v_pk_mul_f32 v[128:129], v[128:129], v[58:59] op_sel_hi:[1,0]
    v_pk_mul_f32 v[140:141], v[140:141], v[56:57] op_sel:[0,1] op_sel_hi:[1,1]
    v_pk_mul_f32 v[130:131], v[130:131], v[58:59] op_sel_hi:[1,0]
    v_pk_mul_f32 v[142:143], v[142:143], v[56:57] op_sel:[0,1] op_sel_hi:[1,1]
    v_exp_f32 v128, v128
    v_exp_f32 v129, v129
    v_exp_f32 v130, v130
    v_exp_f32 v131, v131
    s_nop 0
    v_pk_add_f32 v[128:129], v[128:129], v[72:73]
    v_pk_add_f32 v[130:131], v[130:131], v[72:73]
    v_rcp_f32 v128, v128
    v_rcp_f32 v129, v129
    v_rcp_f32 v130, v130
    v_rcp_f32 v131, v131
    s_nop 0
    v_pk_mul_f32 v[128:129], v[128:129], v[140:141]
    v_pk_mul_f32 v[130:131], v[130:131], v[142:143]
    v_cvt_pk_bf16_f32 v140, v128, v129
    v_cvt_pk_bf16_f32 v141, v130, v131
    buffer_store_dwordx2 v[140:141], v5, s[44:47], s54 offen offset:0
    v_pk_fma_f32 v[132:133], v[36:37], v[56:57], v[132:133] op_sel_hi:[1,0,1]
    v_pk_fma_f32 v[144:145], v[48:49], v[56:57], v[144:145] op_sel_hi:[1,0,1]
    v_pk_fma_f32 v[134:135], v[38:39], v[56:57], v[134:135] op_sel_hi:[1,0,1]
    v_pk_fma_f32 v[146:147], v[50:51], v[56:57], v[146:147] op_sel_hi:[1,0,1]
    v_pk_mul_f32 v[132:133], v[132:133], v[58:59] op_sel_hi:[1,0]
    v_pk_mul_f32 v[144:145], v[144:145], v[56:57] op_sel:[0,1] op_sel_hi:[1,1]
    v_pk_mul_f32 v[134:135], v[134:135], v[58:59] op_sel_hi:[1,0]
    v_pk_mul_f32 v[146:147], v[146:147], v[56:57] op_sel:[0,1] op_sel_hi:[1,1]
    v_exp_f32 v132, v132
    v_exp_f32 v133, v133
    v_exp_f32 v134, v134
    v_exp_f32 v135, v135
    s_nop 0
    v_pk_add_f32 v[132:133], v[132:133], v[72:73]
    v_pk_add_f32 v[134:135], v[134:135], v[72:73]
    v_rcp_f32 v132, v132
    v_rcp_f32 v133, v133
    v_rcp_f32 v134, v134
    v_rcp_f32 v135, v135
    s_nop 0
    v_pk_mul_f32 v[132:133], v[132:133], v[144:145]
    v_pk_mul_f32 v[134:135], v[134:135], v[146:147]
    v_cvt_pk_bf16_f32 v144, v132, v133
    v_cvt_pk_bf16_f32 v145, v134, v135
    buffer_store_dwordx2 v[144:145], v5, s[44:47], s54 offen offset:512
    v_pk_fma_f32 v[136:137], v[40:41], v[56:57], v[136:137] op_sel_hi:[1,0,1]
    v_pk_fma_f32 v[148:149], v[52:53], v[56:57], v[148:149] op_sel_hi:[1,0,1]
    v_pk_fma_f32 v[138:139], v[42:43], v[56:57], v[138:139] op_sel_hi:[1,0,1]
    v_pk_fma_f32 v[150:151], v[54:55], v[56:57], v[150:151] op_sel_hi:[1,0,1]
    v_pk_mul_f32 v[136:137], v[136:137], v[58:59] op_sel_hi:[1,0]
    v_pk_mul_f32 v[148:149], v[148:149], v[56:57] op_sel:[0,1] op_sel_hi:[1,1]
    v_pk_mul_f32 v[138:139], v[138:139], v[58:59] op_sel_hi:[1,0]
    v_pk_mul_f32 v[150:151], v[150:151], v[56:57] op_sel:[0,1] op_sel_hi:[1,1]
    v_exp_f32 v136, v136
    v_exp_f32 v137, v137
    v_exp_f32 v138, v138
    v_exp_f32 v139, v139
    s_nop 0
    v_pk_add_f32 v[136:137], v[136:137], v[72:73]
    v_pk_add_f32 v[138:139], v[138:139], v[72:73]
    v_rcp_f32 v136, v136
    v_rcp_f32 v137, v137
    v_rcp_f32 v138, v138
    v_rcp_f32 v139, v139
    s_nop 0
    v_pk_mul_f32 v[136:137], v[136:137], v[148:149]
    v_pk_mul_f32 v[138:139], v[138:139], v[150:151]
    v_cvt_pk_bf16_f32 v148, v136, v137
    v_cvt_pk_bf16_f32 v149, v138, v139
    buffer_store_dwordx2 v[148:149], v5, s[44:47], s54 offen offset:1024
    s_mul_i32 s54, s37, 34
    v_pk_fma_f32 v[152:153], v[32:33], v[60:61], v[152:153] op_sel_hi:[1,0,1]
    v_pk_fma_f32 v[164:165], v[44:45], v[60:61], v[164:165] op_sel_hi:[1,0,1]
    v_pk_fma_f32 v[154:155], v[34:35], v[60:61], v[154:155] op_sel_hi:[1,0,1]
    v_pk_fma_f32 v[166:167], v[46:47], v[60:61], v[166:167] op_sel_hi:[1,0,1]
    v_pk_mul_f32 v[152:153], v[152:153], v[62:63] op_sel_hi:[1,0]
    v_pk_mul_f32 v[164:165], v[164:165], v[60:61] op_sel:[0,1] op_sel_hi:[1,1]
    v_pk_mul_f32 v[154:155], v[154:155], v[62:63] op_sel_hi:[1,0]
    v_pk_mul_f32 v[166:167], v[166:167], v[60:61] op_sel:[0,1] op_sel_hi:[1,1]
    v_exp_f32 v152, v152
    v_exp_f32 v153, v153
    v_exp_f32 v154, v154
    v_exp_f32 v155, v155
    s_nop 0
    v_pk_add_f32 v[152:153], v[152:153], v[72:73]
    v_pk_add_f32 v[154:155], v[154:155], v[72:73]
    v_rcp_f32 v152, v152
    v_rcp_f32 v153, v153
    v_rcp_f32 v154, v154
    v_rcp_f32 v155, v155
    s_nop 0
    v_pk_mul_f32 v[152:153], v[152:153], v[164:165]
    v_pk_mul_f32 v[154:155], v[154:155], v[166:167]
    v_cvt_pk_bf16_f32 v164, v152, v153
    v_cvt_pk_bf16_f32 v165, v154, v155
    buffer_store_dwordx2 v[164:165], v5, s[44:47], s54 offen offset:0
    v_pk_fma_f32 v[156:157], v[36:37], v[60:61], v[156:157] op_sel_hi:[1,0,1]
    v_pk_fma_f32 v[168:169], v[48:49], v[60:61], v[168:169] op_sel_hi:[1,0,1]
    v_pk_fma_f32 v[158:159], v[38:39], v[60:61], v[158:159] op_sel_hi:[1,0,1]
    v_pk_fma_f32 v[170:171], v[50:51], v[60:61], v[170:171] op_sel_hi:[1,0,1]
    v_pk_mul_f32 v[156:157], v[156:157], v[62:63] op_sel_hi:[1,0]
    v_pk_mul_f32 v[168:169], v[168:169], v[60:61] op_sel:[0,1] op_sel_hi:[1,1]
    v_pk_mul_f32 v[158:159], v[158:159], v[62:63] op_sel_hi:[1,0]
    v_pk_mul_f32 v[170:171], v[170:171], v[60:61] op_sel:[0,1] op_sel_hi:[1,1]
    v_exp_f32 v156, v156
    v_exp_f32 v157, v157
    v_exp_f32 v158, v158
    v_exp_f32 v159, v159
    s_nop 0
    v_pk_add_f32 v[156:157], v[156:157], v[72:73]
    v_pk_add_f32 v[158:159], v[158:159], v[72:73]
    v_rcp_f32 v156, v156
    v_rcp_f32 v157, v157
    v_rcp_f32 v158, v158
    v_rcp_f32 v159, v159
    s_nop 0
    v_pk_mul_f32 v[156:157], v[156:157], v[168:169]
    v_pk_mul_f32 v[158:159], v[158:159], v[170:171]
    v_cvt_pk_bf16_f32 v168, v156, v157
    v_cvt_pk_bf16_f32 v169, v158, v159
    buffer_store_dwordx2 v[168:169], v5, s[44:47], s54 offen offset:512
    v_pk_fma_f32 v[160:161], v[40:41], v[60:61], v[160:161] op_sel_hi:[1,0,1]
    v_pk_fma_f32 v[172:173], v[52:53], v[60:61], v[172:173] op_sel_hi:[1,0,1]
    v_pk_fma_f32 v[162:163], v[42:43], v[60:61], v[162:163] op_sel_hi:[1,0,1]
    v_pk_fma_f32 v[174:175], v[54:55], v[60:61], v[174:175] op_sel_hi:[1,0,1]
    v_pk_mul_f32 v[160:161], v[160:161], v[62:63] op_sel_hi:[1,0]
    v_pk_mul_f32 v[172:173], v[172:173], v[60:61] op_sel:[0,1] op_sel_hi:[1,1]
    v_pk_mul_f32 v[162:163], v[162:163], v[62:63] op_sel_hi:[1,0]
    v_pk_mul_f32 v[174:175], v[174:175], v[60:61] op_sel:[0,1] op_sel_hi:[1,1]
    v_exp_f32 v160, v160
    v_exp_f32 v161, v161
    v_exp_f32 v162, v162
    v_exp_f32 v163, v163
    s_nop 0
    v_pk_add_f32 v[160:161], v[160:161], v[72:73]
    v_pk_add_f32 v[162:163], v[162:163], v[72:73]
    v_rcp_f32 v160, v160
    v_rcp_f32 v161, v161
    v_rcp_f32 v162, v162
    v_rcp_f32 v163, v163
    s_nop 0
    v_pk_mul_f32 v[160:161], v[160:161], v[172:173]
    v_pk_mul_f32 v[162:163], v[162:163], v[174:175]
    v_cvt_pk_bf16_f32 v172, v160, v161
    v_cvt_pk_bf16_f32 v173, v162, v163
    buffer_store_dwordx2 v[172:173], v5, s[44:47], s54 offen offset:1024
    s_mul_i32 s54, s38, 34
    v_pk_fma_f32 v[176:177], v[32:33], v[64:65], v[176:177] op_sel_hi:[1,0,1]
    v_pk_fma_f32 v[188:189], v[44:45], v[64:65], v[188:189] op_sel_hi:[1,0,1]
    v_pk_fma_f32 v[178:179], v[34:35], v[64:65], v[178:179] op_sel_hi:[1,0,1]
    v_pk_fma_f32 v[190:191], v[46:47], v[64:65], v[190:191] op_sel_hi:[1,0,1]
    v_pk_mul_f32 v[176:177], v[176:177], v[66:67] op_sel_hi:[1,0]
    v_pk_mul_f32 v[188:189], v[188:189], v[64:65] op_sel:[0,1] op_sel_hi:[1,1]
    v_pk_mul_f32 v[178:179], v[178:179], v[66:67] op_sel_hi:[1,0]
    v_pk_mul_f32 v[190:191], v[190:191], v[64:65] op_sel:[0,1] op_sel_hi:[1,1]
    v_exp_f32 v176, v176
    v_exp_f32 v177, v177
    v_exp_f32 v178, v178
    v_exp_f32 v179, v179
    s_nop 0
    v_pk_add_f32 v[176:177], v[176:177], v[72:73]
    v_pk_add_f32 v[178:179], v[178:179], v[72:73]
    v_rcp_f32 v176, v176
    v_rcp_f32 v177, v177
    v_rcp_f32 v178, v178
    v_rcp_f32 v179, v179
    s_nop 0
    v_pk_mul_f32 v[176:177], v[176:177], v[188:189]
    v_pk_mul_f32 v[178:179], v[178:179], v[190:191]
    v_cvt_pk_bf16_f32 v188, v176, v177
    v_cvt_pk_bf16_f32 v189, v178, v179
    buffer_store_dwordx2 v[188:189], v5, s[44:47], s54 offen offset:0
    v_pk_fma_f32 v[180:181], v[36:37], v[64:65], v[180:181] op_sel_hi:[1,0,1]
    v_pk_fma_f32 v[192:193], v[48:49], v[64:65], v[192:193] op_sel_hi:[1,0,1]
    v_pk_fma_f32 v[182:183], v[38:39], v[64:65], v[182:183] op_sel_hi:[1,0,1]
    v_pk_fma_f32 v[194:195], v[50:51], v[64:65], v[194:195] op_sel_hi:[1,0,1]
    v_pk_mul_f32 v[180:181], v[180:181], v[66:67] op_sel_hi:[1,0]
    v_pk_mul_f32 v[192:193], v[192:193], v[64:65] op_sel:[0,1] op_sel_hi:[1,1]
    v_pk_mul_f32 v[182:183], v[182:183], v[66:67] op_sel_hi:[1,0]
    v_pk_mul_f32 v[194:195], v[194:195], v[64:65] op_sel:[0,1] op_sel_hi:[1,1]
    v_exp_f32 v180, v180
    v_exp_f32 v181, v181
    v_exp_f32 v182, v182
    v_exp_f32 v183, v183
    s_nop 0
    v_pk_add_f32 v[180:181], v[180:181], v[72:73]
    v_pk_add_f32 v[182:183], v[182:183], v[72:73]
    v_rcp_f32 v180, v180
    v_rcp_f32 v181, v181
    v_rcp_f32 v182, v182
    v_rcp_f32 v183, v183
    s_nop 0
    v_pk_mul_f32 v[180:181], v[180:181], v[192:193]
    v_pk_mul_f32 v[182:183], v[182:183], v[194:195]
    v_cvt_pk_bf16_f32 v192, v180, v181
    v_cvt_pk_bf16_f32 v193, v182, v183
    buffer_store_dwordx2 v[192:193], v5, s[44:47], s54 offen offset:512
    v_pk_fma_f32 v[184:185], v[40:41], v[64:65], v[184:185] op_sel_hi:[1,0,1]
    v_pk_fma_f32 v[196:197], v[52:53], v[64:65], v[196:197] op_sel_hi:[1,0,1]
    v_pk_fma_f32 v[186:187], v[42:43], v[64:65], v[186:187] op_sel_hi:[1,0,1]
    v_pk_fma_f32 v[198:199], v[54:55], v[64:65], v[198:199] op_sel_hi:[1,0,1]
    v_pk_mul_f32 v[184:185], v[184:185], v[66:67] op_sel_hi:[1,0]
    v_pk_mul_f32 v[196:197], v[196:197], v[64:65] op_sel:[0,1] op_sel_hi:[1,1]
    v_pk_mul_f32 v[186:187], v[186:187], v[66:67] op_sel_hi:[1,0]
    v_pk_mul_f32 v[198:199], v[198:199], v[64:65] op_sel:[0,1] op_sel_hi:[1,1]
    v_exp_f32 v184, v184
    v_exp_f32 v185, v185
    v_exp_f32 v186, v186
    v_exp_f32 v187, v187
    s_nop 0
    v_pk_add_f32 v[184:185], v[184:185], v[72:73]
    v_pk_add_f32 v[186:187], v[186:187], v[72:73]
    v_rcp_f32 v184, v184
    v_rcp_f32 v185, v185
    v_rcp_f32 v186, v186
    v_rcp_f32 v187, v187
    s_nop 0
    v_pk_mul_f32 v[184:185], v[184:185], v[196:197]
    v_pk_mul_f32 v[186:187], v[186:187], v[198:199]
    v_cvt_pk_bf16_f32 v196, v184, v185
    v_cvt_pk_bf16_f32 v197, v186, v187
    buffer_store_dwordx2 v[196:197], v5, s[44:47], s54 offen offset:1024
    s_mul_i32 s54, s39, 34
    v_pk_fma_f32 v[200:201], v[32:33], v[68:69], v[200:201] op_sel_hi:[1,0,1]
    v_pk_fma_f32 v[212:213], v[44:45], v[68:69], v[212:213] op_sel_hi:[1,0,1]
    v_pk_fma_f32 v[202:203], v[34:35], v[68:69], v[202:203] op_sel_hi:[1,0,1]
    v_pk_fma_f32 v[214:215], v[46:47], v[68:69], v[214:215] op_sel_hi:[1,0,1]
    v_pk_mul_f32 v[200:201], v[200:201], v[70:71] op_sel_hi:[1,0]
    v_pk_mul_f32 v[212:213], v[212:213], v[68:69] op_sel:[0,1] op_sel_hi:[1,1]
    v_pk_mul_f32 v[202:203], v[202:203], v[70:71] op_sel_hi:[1,0]
    v_pk_mul_f32 v[214:215], v[214:215], v[68:69] op_sel:[0,1] op_sel_hi:[1,1]
    v_exp_f32 v200, v200
    v_exp_f32 v201, v201
    v_exp_f32 v202, v202
    v_exp_f32 v203, v203
    s_nop 0
    v_pk_add_f32 v[200:201], v[200:201], v[72:73]
    v_pk_add_f32 v[202:203], v[202:203], v[72:73]
    v_rcp_f32 v200, v200
    v_rcp_f32 v201, v201
    v_rcp_f32 v202, v202
    v_rcp_f32 v203, v203
    s_nop 0
    v_pk_mul_f32 v[200:201], v[200:201], v[212:213]
    v_pk_mul_f32 v[202:203], v[202:203], v[214:215]
    v_cvt_pk_bf16_f32 v212, v200, v201
    v_cvt_pk_bf16_f32 v213, v202, v203
    buffer_store_dwordx2 v[212:213], v5, s[44:47], s54 offen offset:0
    v_pk_fma_f32 v[204:205], v[36:37], v[68:69], v[204:205] op_sel_hi:[1,0,1]
    v_pk_fma_f32 v[216:217], v[48:49], v[68:69], v[216:217] op_sel_hi:[1,0,1]
    v_pk_fma_f32 v[206:207], v[38:39], v[68:69], v[206:207] op_sel_hi:[1,0,1]
    v_pk_fma_f32 v[218:219], v[50:51], v[68:69], v[218:219] op_sel_hi:[1,0,1]
    v_pk_mul_f32 v[204:205], v[204:205], v[70:71] op_sel_hi:[1,0]
    v_pk_mul_f32 v[216:217], v[216:217], v[68:69] op_sel:[0,1] op_sel_hi:[1,1]
    v_pk_mul_f32 v[206:207], v[206:207], v[70:71] op_sel_hi:[1,0]
    v_pk_mul_f32 v[218:219], v[218:219], v[68:69] op_sel:[0,1] op_sel_hi:[1,1]
    v_exp_f32 v204, v204
    v_exp_f32 v205, v205
    v_exp_f32 v206, v206
    v_exp_f32 v207, v207
    s_nop 0
    v_pk_add_f32 v[204:205], v[204:205], v[72:73]
    v_pk_add_f32 v[206:207], v[206:207], v[72:73]
    v_rcp_f32 v204, v204
    v_rcp_f32 v205, v205
    v_rcp_f32 v206, v206
    v_rcp_f32 v207, v207
    s_nop 0
    v_pk_mul_f32 v[204:205], v[204:205], v[216:217]
    v_pk_mul_f32 v[206:207], v[206:207], v[218:219]
    v_cvt_pk_bf16_f32 v216, v204, v205
    v_cvt_pk_bf16_f32 v217, v206, v207
    buffer_store_dwordx2 v[216:217], v5, s[44:47], s54 offen offset:512
    v_pk_fma_f32 v[208:209], v[40:41], v[68:69], v[208:209] op_sel_hi:[1,0,1]
    v_pk_fma_f32 v[220:221], v[52:53], v[68:69], v[220:221] op_sel_hi:[1,0,1]
    v_pk_fma_f32 v[210:211], v[42:43], v[68:69], v[210:211] op_sel_hi:[1,0,1]
    v_pk_fma_f32 v[222:223], v[54:55], v[68:69], v[222:223] op_sel_hi:[1,0,1]
    v_pk_mul_f32 v[208:209], v[208:209], v[70:71] op_sel_hi:[1,0]
    v_pk_mul_f32 v[220:221], v[220:221], v[68:69] op_sel:[0,1] op_sel_hi:[1,1]
    v_pk_mul_f32 v[210:211], v[210:211], v[70:71] op_sel_hi:[1,0]
    v_pk_mul_f32 v[222:223], v[222:223], v[68:69] op_sel:[0,1] op_sel_hi:[1,1]
    v_exp_f32 v208, v208
    v_exp_f32 v209, v209
    v_exp_f32 v210, v210
    v_exp_f32 v211, v211
    s_nop 0
    v_pk_add_f32 v[208:209], v[208:209], v[72:73]
    v_pk_add_f32 v[210:211], v[210:211], v[72:73]
    v_rcp_f32 v208, v208
    v_rcp_f32 v209, v209
    v_rcp_f32 v210, v210
    v_rcp_f32 v211, v211
    s_nop 0
    v_pk_mul_f32 v[208:209], v[208:209], v[220:221]
    v_pk_mul_f32 v[210:211], v[210:211], v[222:223]
    v_cvt_pk_bf16_f32 v220, v208, v209
    v_cvt_pk_bf16_f32 v221, v210, v211
    buffer_store_dwordx2 v[220:221], v5, s[44:47], s54 offen offset:1024
    s_endpgm
k1_qkv:
    s_lshl_b32 s52, s8, 4
    s_add_u32 s52, s52, s7
    v_lshrrev_b32 v1, 3, v2
    v_add_u32 v5, s52, v1
    v_mul_u32_u24 v5, 1280, v5
    v_and_b32 v6, 7, v2
    v_xor_b32 v7, v6, v4
    v_lshl_add_u32 v123, v7, 4, v5
    v_or_b32 v7, 4, v4
    v_xor_b32 v7, v6, v7
    v_lshl_add_u32 v124, v7, 4, v5
    v_add_u32 v124, 9216, v124
    s_and_b32 s53, s8, 1
    s_lshl_b32 s54, s53, 3
    s_add_u32 s54, s54, s7
    s_sub_u32 s54, s54, 16
    v_add_u32 v5, s54, v1
    s_mov_b32 s54, 1280
    v_mul_lo_u32 v5, v5, s54
    s_lshl_b32 s54, s53, 2
    v_or_b32 v7, s54, v4
    v_xor_b32 v7, v6, v7
    v_lshl_add_u32 v125, v7, 4, v5
    s_lshl_b32 s56, s8, 11
    s_add_u32 s56, s56, 2048
    s_lshl_b32 s58, s53, 10
    s_mul_i32 s54, s4, 160
    s_lshl_b32 s52, s8, 7
    v_add_u32 v5, s52, v2
    v_mul_u32_u24 v6, 1058, v5
    v_lshrrev_b32 v6, 18, v6
    v_mul_u32_u24 v7, 248, v6
    v_sub_u32 v5, v5, v7
    v_mul_u32_u24 v7, 2185, v5
    v_lshrrev_b32 v7, 16, v7
    v_lshl_add_u32 v6, v6, 3, v7
    v_mul_u32_u24 v7, 30, v7
    v_sub_u32 v7, v5, v7
    v_mul_u32_u24 v1, 26, v7
    v_lshrrev_b32 v1, 8, v1
    v_mul_u32_u24 v1, 1120, v1
    v_lshl_add_u32 v1, v7, 4, v1
    v_cmp_gt_u32 vcc, 240, v5
    v_mul_u32_u24 v7, 3840, v6
    v_add_u32 v1, v1, v7
    v_add_u32 v1, s54, v1
    v_mov_b32 v7, 0x7f000000
    v_cndmask_b32 v1, v7, v1, vcc
    v_cmp_gt_u32 vcc, 32, v6
    s_nop 1
    v_cndmask_b32 v126, v7, v1, vcc
    v_add_u32 v5, s52, v2
    v_add_u32 v5, 64, v5
    v_mul_u32_u24 v6, 1058, v5
    v_lshrrev_b32 v6, 18, v6
    v_mul_u32_u24 v7, 248, v6
    v_sub_u32 v5, v5, v7
    v_mul_u32_u24 v7, 2185, v5
    v_lshrrev_b32 v7, 16, v7
    v_lshl_add_u32 v6, v6, 3, v7
    v_mul_u32_u24 v7, 30, v7
    v_sub_u32 v7, v5, v7
    v_mul_u32_u24 v1, 26, v7
    v_lshrrev_b32 v1, 8, v1
    v_mul_u32_u24 v1, 1120, v1
    v_lshl_add_u32 v1, v7, 4, v1
    v_cmp_gt_u32 vcc, 240, v5
    v_mul_u32_u24 v7, 3840, v6
    v_add_u32 v1, v1, v7
    v_add_u32 v1, s54, v1
    v_subrev_u32 v1, 1024, v1
    v_mov_b32 v7, 0x7f000000
    v_cndmask_b32 v1, v7, v1, vcc
    v_cmp_gt_u32 vcc, 32, v6
    s_nop 1
    v_cndmask_b32 v127, v7, v1, vcc
    s_lshl_b32 s57, s8, 11
    s_waitcnt lgkmcnt(0)
    s_sub_u32 s90, s90, 600
    s_mov_b32 s40, s16
    s_and_b32 s41, s17, 0xffff
    s_mov_b32 s42, 2621440
    s_mov_b32 s43, 0x20000
    s_mov_b32 s44, s34
    s_and_b32 s45, s35, 0xffff
    s_mov_b32 s46, 11698176
    s_mov_b32 s47, 0x20000
    s_mov_b32 s48, s18
    s_and_b32 s49, s19, 0xffff
    s_mov_b32 s50, 2457600
    s_mov_b32 s51, 0x20000
    s_lshr_b32 s3, s5, 2
    s_mul_i32 s3, s3, 5
    s_lshr_b32 s3, s3, 1
    s_lshl_b32 s13, s3, 7
    s_mul_i32 s14, s3, 245760
    s_mov_b32 s55, 0
    s_add_u32 m0, s55, s56
    s_nop 0
    buffer_load_dwordx4 v123, s[40:43], s13 offen offset:0 lds
    buffer_load_dwordx4 v124, s[40:43], s13 offen offset:1024 lds
    s_add_u32 m0, s55, s58
    s_nop 0
    buffer_load_dwordx4 v125, s[40:43], s13 offen offset:0 lds
    s_add_u32 s13, s13, 128
    s_cmp_eq_u32 s13, 1280
    s_cselect_b32 s13, 0, s13
    s_mov_b32 s55, 55296
    s_add_u32 m0, s55, s57
    s_nop 0
    buffer_load_dwordx4 v126, s[48:51], s14 offen offset:0 lds
    buffer_load_dwordx4 v127, s[48:51], s14 offen offset:1024 lds
    s_add_u32 s14, s14, 122880
    s_cmp_eq_u32 s14, 2457600
    s_cselect_b32 s14, 0, s14
    s_mov_b32 s55, 18432
    s_add_u32 m0, s55, s56
    s_nop 0
    buffer_load_dwordx4 v123, s[40:43], s13 offen offset:0 lds
    buffer_load_dwordx4 v124, s[40:43], s13 offen offset:1024 lds
    s_add_u32 m0, s55, s58
    s_nop 0
    buffer_load_dwordx4 v125, s[40:43], s13 offen offset:0 lds
    s_add_u32 s13, s13, 128
    s_cmp_eq_u32 s13, 1280
    s_cselect_b32 s13, 0, s13
    s_mov_b32 s55, 71680
    s_add_u32 m0, s55, s57
    s_nop 0
    buffer_load_dwordx4 v126, s[48:51], s14 offen offset:0 lds
    buffer_load_dwordx4 v127, s[48:51], s14 offen offset:1024 lds
    s_add_u32 s14, s14, 122880
    s_cmp_eq_u32 s14, 2457600
    s_cselect_b32 s14, 0, s14
    s_and_b32 s91, s2, 1
    s_lshl_b32 s91, s91, 3
    s_lshr_b32 s3, s2, 5
    s_add_u32 s91, s91, s3
    s_lshl_b32 s91, s91, 3
    s_add_u32 s91, s91, s7
    s_add_u32 s91, s91, s8
    v_mul_u32_u24 v13, 20, v2
    s_mul_i32 s3, s91, 1280
    v_add_u32 v27, s3, v13
    buffer_load_dwordx4 v[240:243], v27, s[40:43], 0 offen
    buffer_load_dword v244, v27, s[40:43], 0 offen offset:16
    s_add_u32 s92, s34, 11698176
    s_addc_u32 s93, s35, 0
    s_and_b32 s93, s93, 0xffff
    s_mov_b32 s94, 32768
    s_mov_b32 s95, 0x20000
    v_lshrrev_b32 v6, 1, v3
    v_xor_b32 v6, v6, v4
    v_lshlrev_b32 v6, 4, v6
    v_lshl_add_u32 v112, v3, 7, v6
    v_xor_b32 v113, 64, v112
    s_lshr_b32 s54, s8, 2
    s_lshl_b32 s36, s54, 13
    s_add_u32 s36, s36, 2048
    v_add_u32 v110, s36, v112
    v_add_u32 v111, s36, v113
    v_lshrrev_b32 v5, 2, v3
    v_mul_u32_u24 v5, 30, v5
    v_mul_u32_u24 v6, 248, v4
    v_add_u32 v5, v5, v6
    v_lshrrev_b32 v6, 1, v2
    v_and_b32 v6, 1, v6
    v_add_u32 v5, v5, v6
    v_lshlrev_b32 v5, 4, v5
    v_and_b32 v6, 1, v2
    v_lshl_add_u32 v5, v6, 3, v5
    s_and_b32 s55, s8, 3
    s_lshl_b32 s55, s55, 7
    v_add_u32 v114, s55, v5
    v_mov_b32 v248, 0x3f803f80
    v_mov_b32 v249, 0x3f803f80
    v_mov_b32 v250, 0x3f803f80
    v_mov_b32 v251, 0x3f803f80
    v_mov_b32 v128, 0
    v_mov_b32 v129, 0
    v_mov_b32 v130, 0
    v_mov_b32 v131, 0
    v_mov_b32 v132, 0
    v_mov_b32 v133, 0
    v_mov_b32 v134, 0
    v_mov_b32 v135, 0
    v_mov_b32 v136, 0
    v_mov_b32 v137, 0
    v_mov_b32 v138, 0
    v_mov_b32 v139, 0
    v_mov_b32 v140, 0
    v_mov_b32 v141, 0
    v_mov_b32 v142, 0
    v_mov_b32 v143, 0
    v_mov_b32 v144, 0
    v_mov_b32 v145, 0
    v_mov_b32 v146, 0
    v_mov_b32 v147, 0
    v_mov_b32 v148, 0
    v_mov_b32 v149, 0
    v_mov_b32 v150, 0
    v_mov_b32 v151, 0
    v_mov_b32 v152, 0
    v_mov_b32 v153, 0
    v_mov_b32 v154, 0
    v_mov_b32 v155, 0
    v_mov_b32 v156, 0
    v_mov_b32 v157, 0
    v_mov_b32 v158, 0
    v_mov_b32 v159, 0
    v_mov_b32 v160, 0
    v_mov_b32 v161, 0
    v_mov_b32 v162, 0
    v_mov_b32 v163, 0
    v_mov_b32 v164, 0
    v_mov_b32 v165, 0
    v_mov_b32 v166, 0
    v_mov_b32 v167, 0
    v_mov_b32 v168, 0
    v_mov_b32 v169, 0
    v_mov_b32 v170, 0
    v_mov_b32 v171, 0
    v_mov_b32 v172, 0
    v_mov_b32 v173, 0
    v_mov_b32 v174, 0
    v_mov_b32 v175, 0
    v_mov_b32 v176, 0
    v_mov_b32 v177, 0
    v_mov_b32 v178, 0
    v_mov_b32 v179, 0
    v_mov_b32 v180, 0
    v_mov_b32 v181, 0
    v_mov_b32 v182, 0
    v_mov_b32 v183, 0
    v_mov_b32 v184, 0
    v_mov_b32 v185, 0
    v_mov_b32 v186, 0
    v_mov_b32 v187, 0
    v_mov_b32 v188, 0
    v_mov_b32 v189, 0
    v_mov_b32 v190, 0
    v_mov_b32 v191, 0
    v_mov_b32 v192, 0
    v_mov_b32 v193, 0
    v_mov_b32 v194, 0
    v_mov_b32 v195, 0
    v_mov_b32 v196, 0
    v_mov_b32 v197, 0
    v_mov_b32 v198, 0
    v_mov_b32 v199, 0
    v_mov_b32 v224, 0
    v_mov_b32 v225, 0
    v_mov_b32 v226, 0
    v_mov_b32 v227, 0
    v_mov_b32 v228, 0
    v_mov_b32 v229, 0
    v_mov_b32 v230, 0
    v_mov_b32 v231, 0
    s_mov_b32 s55, 88064
    s_add_u32 m0, s55, s57
    s_nop 0
    buffer_load_dwordx4 v126, s[48:51], s14 offen offset:0 lds
    buffer_load_dwordx4 v127, s[48:51], s14 offen offset:1024 lds
    s_add_u32 s14, s14, 122880
    s_cmp_eq_u32 s14, 2457600
    s_cselect_b32 s14, 0, s14
    s_mov_b32 s55, 36864
    s_add_u32 m0, s55, s56
    s_nop 0
    buffer_load_dwordx4 v123, s[40:43], s13 offen offset:0 lds
    buffer_load_dwordx4 v124, s[40:43], s13 offen offset:1024 lds
    s_add_u32 m0, s55, s58
    s_nop 0
    buffer_load_dwordx4 v125, s[40:43], s13 offen offset:0 lds
    s_add_u32 s13, s13, 128
    s_cmp_eq_u32 s13, 1280
    s_cselect_b32 s13, 0, s13
    s_mov_b32 s55, 104448
    s_add_u32 m0, s55, s57
    s_nop 0
    buffer_load_dwordx4 v126, s[48:51], s14 offen offset:0 lds
    buffer_load_dwordx4 v127, s[48:51], s14 offen offset:1024 lds
    s_add_u32 s14, s14, 122880
    s_cmp_eq_u32 s14, 2457600
    s_cselect_b32 s14, 0, s14
    s_mov_b32 s9, 0
    s_mov_b32 s10, 18432
    s_mov_b32 s12, 55296
    s_mov_b32 s11, 71680
    s_mov_b32 s15, 0
    s_cmp_lt_u32 s8, 4
    s_cselect_b64 vcc, -1, 0
    s_waitcnt vmcnt(14)
    s_barrier
    v_add_u32 v117, s9, v110
    v_add_u32 v118, s9, v112
    v_add_u32 v120, s12, v114
    ds_read_b128 v[8:11], v117 offset:0
    ds_read_b128 v[12:15], v117 offset:2048
    ds_read_b128 v[16:19], v117 offset:4096
    ds_read_b128 v[20:23], v117 offset:6144
    ds_read_b128 v[24:27], v118 offset:0
    ds_read_b64_tr_b16 v[28:29], v120 offset:0
    ds_read_b64_tr_b16 v[30:31], v120 offset:1920
    ds_read_b64_tr_b16 v[32:33], v120 offset:32
    ds_read_b64_tr_b16 v[34:35], v120 offset:1952
    ds_read_b64_tr_b16 v[36:37], v120 offset:64
    ds_read_b64_tr_b16 v[38:39], v120 offset:1984
    ds_read_b64_tr_b16 v[40:41], v120 offset:96
    ds_read_b64_tr_b16 v[42:43], v120 offset:2016
    s_waitcnt lgkmcnt(0)
qkv_loop:
    s_waitcnt vmcnt(7)
    s_barrier
    v_add_u32 v117, s9, v111
    v_add_u32 v118, s9, v113
    v_add_u32 v120, s11, v114
    v_mfma_f32_16x16x32_bf16 v[128:131], v[28:31], v[8:11], v[128:131]
    ds_read_b128 v[44:47], v117 offset:0
    v_mfma_f32_16x16x32_bf16 v[132:135], v[28:31], v[12:15], v[132:135]
    ds_read_b128 v[48:51], v117 offset:2048
    v_mfma_f32_16x16x32_bf16 v[136:139], v[28:31], v[16:19], v[136:139]
    ds_read_b128 v[52:55], v117 offset:4096
    v_mfma_f32_16x16x32_bf16 v[140:143], v[28:31], v[20:23], v[140:143]
    ds_read_b128 v[56:59], v117 offset:6144
    v_mfma_f32_16x16x32_bf16 v[144:147], v[32:35], v[8:11], v[144:147]
    s_add_u32 m0, s12, s57
    s_nop 0
    buffer_load_dwordx4 v126, s[48:51], s14 offen offset:0 lds
qkv_sk_1776:
    ds_read_b128 v[60:63], v118 offset:0
    v_mfma_f32_16x16x32_bf16 v[148:151], v[32:35], v[12:15], v[148:151]
    ds_read_b64_tr_b16 v[64:65], v120 offset:0
    v_mfma_f32_16x16x32_bf16 v[152:155], v[32:35], v[16:19], v[152:155]
    ds_read_b64_tr_b16 v[66:67], v120 offset:1920
    v_mfma_f32_16x16x32_bf16 v[156:159], v[32:35], v[20:23], v[156:159]
    ds_read_b64_tr_b16 v[68:69], v120 offset:32
    v_mfma_f32_16x16x32_bf16 v[160:163], v[36:39], v[8:11], v[160:163]
    ds_read_b64_tr_b16 v[70:71], v120 offset:1952
    v_mfma_f32_16x16x32_bf16 v[164:167], v[36:39], v[12:15], v[164:167]
    ds_read_b64_tr_b16 v[72:73], v120 offset:64
    v_mfma_f32_16x16x32_bf16 v[168:171], v[36:39], v[16:19], v[168:171]
    ds_read_b64_tr_b16 v[74:75], v120 offset:1984
    v_mfma_f32_16x16x32_bf16 v[172:175], v[36:39], v[20:23], v[172:175]
    ds_read_b64_tr_b16 v[76:77], v120 offset:96
    v_mfma_f32_16x16x32_bf16 v[176:179], v[40:43], v[8:11], v[176:179]
    s_add_u32 m0, s12, s57
    s_nop 0
    buffer_load_dwordx4 v127, s[48:51], s14 offen offset:1024 lds
    s_add_u32 s14, s14, 122880
    s_cmp_eq_u32 s14, 2457600
    s_cselect_b32 s14, 0, s14
qkv_sk_1796:
    ds_read_b64_tr_b16 v[78:79], v120 offset:2016
    v_mfma_f32_16x16x32_bf16 v[180:183], v[40:43], v[12:15], v[180:183]
    v_mfma_f32_16x16x32_bf16 v[184:187], v[40:43], v[16:19], v[184:187]
    v_mfma_f32_16x16x32_bf16 v[188:191], v[40:43], v[20:23], v[188:191]
    s_cbranch_vccz qkv_cb_1767_0
    v_mfma_f32_16x16x32_bf16 v[192:195], v[28:31], v[24:27], v[192:195]
    v_mfma_f32_16x16x32_bf16 v[224:227], v[28:31], v[248:251], v[224:227]
    v_mfma_f32_16x16x32_bf16 v[196:199], v[32:35], v[24:27], v[196:199]
    v_mfma_f32_16x16x32_bf16 v[228:231], v[32:35], v[248:251], v[228:231]
    s_branch qkv_cj_1767_0
qkv_cb_1767_0:
    v_mfma_f32_16x16x32_bf16 v[192:195], v[36:39], v[24:27], v[192:195]
    v_mfma_f32_16x16x32_bf16 v[224:227], v[36:39], v[248:251], v[224:227]
    v_mfma_f32_16x16x32_bf16 v[196:199], v[40:43], v[24:27], v[196:199]
    v_mfma_f32_16x16x32_bf16 v[228:231], v[40:43], v[248:251], v[228:231]
qkv_cj_1767_0:
    s_mov_b32 s12, s11
    s_add_u32 s11, s11, 16384
    s_cmp_ge_u32 s11, 120832
    s_cselect_b32 s11, 55296, s11
    s_waitcnt lgkmcnt(0)
    s_waitcnt vmcnt(7)
    s_barrier
    v_add_u32 v117, s10, v110
    v_add_u32 v118, s10, v112
    v_add_u32 v120, s11, v114
    v_mfma_f32_16x16x32_bf16 v[128:131], v[64:67], v[44:47], v[128:131]
    ds_read_b128 v[8:11], v117 offset:0
    v_mfma_f32_16x16x32_bf16 v[132:135], v[64:67], v[48:51], v[132:135]
    s_cmp_ge_u32 s15, 7
    s_cbranch_scc1 qkv_sk_1832
    s_add_u32 m0, s9, s56
    s_nop 0
    buffer_load_dwordx4 v123, s[40:43], s13 offen offset:0 lds
qkv_sk_1832:
    ds_read_b128 v[12:15], v117 offset:2048
    v_mfma_f32_16x16x32_bf16 v[136:139], v[64:67], v[52:55], v[136:139]
    ds_read_b128 v[16:19], v117 offset:4096
    v_mfma_f32_16x16x32_bf16 v[140:143], v[64:67], v[56:59], v[140:143]
    ds_read_b128 v[20:23], v117 offset:6144
    v_mfma_f32_16x16x32_bf16 v[144:147], v[68:71], v[44:47], v[144:147]
    s_cmp_ge_u32 s15, 7
    s_cbranch_scc1 qkv_sk_1844
    s_add_u32 m0, s9, s56
    s_nop 0
    buffer_load_dwordx4 v124, s[40:43], s13 offen offset:1024 lds
qkv_sk_1844:
    ds_read_b128 v[24:27], v118 offset:0
    v_mfma_f32_16x16x32_bf16 v[148:151], v[68:71], v[48:51], v[148:151]
    ds_read_b64_tr_b16 v[28:29], v120 offset:0
    v_mfma_f32_16x16x32_bf16 v[152:155], v[68:71], v[52:55], v[152:155]
    ds_read_b64_tr_b16 v[30:31], v120 offset:1920
    v_mfma_f32_16x16x32_bf16 v[156:159], v[68:71], v[56:59], v[156:159]
    ds_read_b64_tr_b16 v[32:33], v120 offset:32
    v_mfma_f32_16x16x32_bf16 v[160:163], v[72:75], v[44:47], v[160:163]
    s_cmp_ge_u32 s15, 7
    s_cbranch_scc1 qkv_sk_1858
    s_add_u32 m0, s9, s58
    s_nop 0
    buffer_load_dwordx4 v125, s[40:43], s13 offen offset:0 lds
    s_add_u32 s13, s13, 128
    s_cmp_eq_u32 s13, 1280
    s_cselect_b32 s13, 0, s13
qkv_sk_1858:
    ds_read_b64_tr_b16 v[34:35], v120 offset:1952
    v_mfma_f32_16x16x32_bf16 v[164:167], v[72:75], v[48:51], v[164:167]
    ds_read_b64_tr_b16 v[36:37], v120 offset:64
    v_mfma_f32_16x16x32_bf16 v[168:171], v[72:75], v[52:55], v[168:171]
    ds_read_b64_tr_b16 v[38:39], v120 offset:1984
    v_mfma_f32_16x16x32_bf16 v[172:175], v[72:75], v[56:59], v[172:175]
    s_add_u32 m0, s12, s57
    s_nop 0
    buffer_load_dwordx4 v126, s[48:51], s14 offen offset:0 lds
qkv_sk_1873:
    ds_read_b64_tr_b16 v[40:41], v120 offset:96
    v_mfma_f32_16x16x32_bf16 v[176:179], v[76:79], v[44:47], v[176:179]
    ds_read_b64_tr_b16 v[42:43], v120 offset:2016
    v_mfma_f32_16x16x32_bf16 v[180:183], v[76:79], v[48:51], v[180:183]
    v_mfma_f32_16x16x32_bf16 v[184:187], v[76:79], v[52:55], v[184:187]
    s_add_u32 m0, s12, s57
    s_nop 0
    buffer_load_dwordx4 v127, s[48:51], s14 offen offset:1024 lds
    s_add_u32 s14, s14, 122880
    s_cmp_eq_u32 s14, 2457600
    s_cselect_b32 s14, 0, s14
qkv_sk_1882:
    v_mfma_f32_16x16x32_bf16 v[188:191], v[76:79], v[56:59], v[188:191]
    s_cbranch_vccz qkv_cb_1829_1
    v_mfma_f32_16x16x32_bf16 v[192:195], v[64:67], v[60:63], v[192:195]
    v_mfma_f32_16x16x32_bf16 v[224:227], v[64:67], v[248:251], v[224:227]
    v_mfma_f32_16x16x32_bf16 v[196:199], v[68:71], v[60:63], v[196:199]
    v_mfma_f32_16x16x32_bf16 v[228:231], v[68:71], v[248:251], v[228:231]
    s_branch qkv_cj_1829_1
qkv_cb_1829_1:
    v_mfma_f32_16x16x32_bf16 v[192:195], v[72:75], v[60:63], v[192:195]
    v_mfma_f32_16x16x32_bf16 v[224:227], v[72:75], v[248:251], v[224:227]
    v_mfma_f32_16x16x32_bf16 v[196:199], v[76:79], v[60:63], v[196:199]
    v_mfma_f32_16x16x32_bf16 v[228:231], v[76:79], v[248:251], v[228:231]
qkv_cj_1829_1:
    s_mov_b32 s12, s11
    s_add_u32 s11, s11, 16384
    s_cmp_ge_u32 s11, 120832
    s_cselect_b32 s11, 55296, s11
    s_mov_b32 s9, s10
    s_add_u32 s10, s10, 18432
    s_cmp_ge_u32 s10, 55296
    s_cselect_b32 s10, 0, s10
    s_waitcnt lgkmcnt(0)
    s_cmp_lg_u32 s15, 0
    s_cbranch_scc1 qkv_nolate
    s_memrealtime s[96:97]
    v_mov_b32 v48, v240
    v_mov_b32 v49, v241
    v_mov_b32 v50, v242
    v_mov_b32 v51, v243
    v_mov_b32 v52, v244
    v_lshlrev_b32 v54, 16, v48
    v_and_b32 v55, 0xffff0000, v48
    v_lshlrev_b32 v56, 16, v49
    v_and_b32 v57, 0xffff0000, v49
    v_lshlrev_b32 v58, 16, v50
    v_and_b32 v59, 0xffff0000, v50
    v_lshlrev_b32 v60, 16, v51
    v_and_b32 v61, 0xffff0000, v51
    v_lshlrev_b32 v62, 16, v52
    v_and_b32 v63, 0xffff0000, v52
    v_add_f32 v64, v54, v55
    v_add_f32 v64, v64, v56
    v_add_f32 v64, v64, v57
    v_add_f32 v64, v64, v58
    v_add_f32 v64, v64, v59
    v_add_f32 v64, v64, v60
    v_add_f32 v64, v64, v61
    v_add_f32 v64, v64, v62
    v_add_f32 v64, v64, v63
    s_nop 1
    v_add_f32_dpp v64, v64, v64 quad_perm:[1,0,3,2] row_mask:0xf bank_mask:0xf
    s_nop 1
    v_add_f32_dpp v64, v64, v64 quad_perm:[2,3,0,1] row_mask:0xf bank_mask:0xf
    s_nop 1
    v_add_f32_dpp v64, v64, v64 row_half_mirror row_mask:0xf bank_mask:0xf
    s_nop 1
    v_add_f32_dpp v64, v64, v64 row_mirror row_mask:0xf bank_mask:0xf
    s_nop 1
    v_readlane_b32 s75, v64, 0
    v_readlane_b32 s76, v64, 16
    v_readlane_b32 s77, v64, 32
    v_readlane_b32 s78, v64, 48
    s_nop 1
    v_mov_b32 v64, s75
    v_add_f32 v64, s76, v64
    v_add_f32 v64, s77, v64
    v_add_f32 v64, s78, v64
    v_mul_f32 v64, 0x3acccccd, v64
    v_sub_f32 v66, v54, v64
    v_mul_f32 v65, v66, v66
    v_sub_f32 v66, v55, v64
    v_fmac_f32 v65, v66, v66
    v_sub_f32 v66, v56, v64
    v_fmac_f32 v65, v66, v66
    v_sub_f32 v66, v57, v64
    v_fmac_f32 v65, v66, v66
    v_sub_f32 v66, v58, v64
    v_fmac_f32 v65, v66, v66
    v_sub_f32 v66, v59, v64
    v_fmac_f32 v65, v66, v66
    v_sub_f32 v66, v60, v64
    v_fmac_f32 v65, v66, v66
    v_sub_f32 v66, v61, v64
    v_fmac_f32 v65, v66, v66
    v_sub_f32 v66, v62, v64
    v_fmac_f32 v65, v66, v66
    v_sub_f32 v66, v63, v64
    v_fmac_f32 v65, v66, v66
    s_nop 1
    v_add_f32_dpp v65, v65, v65 quad_perm:[1,0,3,2] row_mask:0xf bank_mask:0xf
    s_nop 1
    v_add_f32_dpp v65, v65, v65 quad_perm:[2,3,0,1] row_mask:0xf bank_mask:0xf
    s_nop 1
    v_add_f32_dpp v65, v65, v65 row_half_mirror row_mask:0xf bank_mask:0xf
    s_nop 1
    v_add_f32_dpp v65, v65, v65 row_mirror row_mask:0xf bank_mask:0xf
    s_nop 1
    v_readlane_b32 s75, v65, 0
    v_readlane_b32 s76, v65, 16
    v_readlane_b32 s77, v65, 32
    v_readlane_b32 s78, v65, 48
    s_nop 1
    v_mov_b32 v65, s75
    v_add_f32 v65, s76, v65
    v_add_f32 v65, s77, v65
    v_add_f32 v65, s78, v65
    v_mul_f32 v65, 0x3acccccd, v65
    v_cvt_pk_bf16_f32 v66, v64, v65
    v_lshlrev_b32 v64, 16, v66
    v_and_b32 v65, 0xffff0000, v66
    v_add_f32 v65, 0x3727c5ac, v65
    v_cvt_pk_bf16_f32 v65, v65, v65
    v_lshlrev_b32 v65, 16, v65
    v_sqrt_f32 v65, v65
    s_nop 0
    v_cvt_pk_bf16_f32 v65, v65, v65
    v_lshlrev_b32 v65, 16, v65
    v_rcp_f32 v65, v65
    s_nop 0
    s_lshl_b32 s3, s91, 4
    v_mov_b32 v66, v65
    v_mov_b32 v68, s3
    s_waitcnt lgkmcnt(0)
    v_mov_b32 v65, s96
    v_mov_b32 v67, s96
    s_mov_b64 exec, 1
    buffer_store_dwordx4 v[64:67], v68, s[92:95], 0 offen sc1
    s_mov_b64 exec, -1
    v_mov_b32 v48, 156416
    v_mov_b32 v49, 0
    ds_write_b32 v48, v49
    s_waitcnt lgkmcnt(0)
    s_lshr_b32 s79, s2, 3
    s_and_b32 s78, s79, 3
    s_lshr_b32 s79, s79, 3
    s_lshl_b32 s79, s79, 2
    s_add_u32 s78, s78, s79
    s_and_b32 s79, s2, 7
    s_lshl_b32 s79, s79, 4
    s_add_u32 s78, s78, s79
    s_lshl_b32 s75, s78, 3
    s_add_u32 s75, s75, s8
    s_min_u32 s79, s75, 679
    s_mul_i32 s76, s79, 6554
    s_lshr_b32 s76, s76, 16
    s_mul_i32 s78, s76, 10
    s_sub_u32 s77, s79, s78
    s_cmp_lt_u32 s76, 20
    s_cselect_b32 s84, s20, s28
    s_cselect_b32 s85, s21, s29
    s_mov_b32 s86, 1966080
    s_cselect_b32 s86, 819200, s86
    s_cselect_b32 s79, 0, 20
    s_and_b32 s85, s85, 0xffff
    s_mov_b32 s87, 0x20000
    s_sub_u32 s79, s76, s79
    s_mul_i32 s79, s79, 40960
    s_lshl_b32 s78, s77, 7
    s_add_u32 s79, s79, s78
    v_lshrrev_b32 v5, 3, v2
    v_and_b32 v6, 7, v2
    v_and_b32 v7, 2, v5
    v_xor_b32 v6, v6, v7
    v_mul_u32_u24 v5, 1280, v5
    v_lshl_add_u32 v232, v6, 4, v5
    v_xor_b32 v6, 4, v6
    v_lshl_add_u32 v233, v6, 4, v5
    s_lshl_b32 s78, s8, 12
    s_add_u32 s78, s78, 120832
    s_add_u32 m0, s78, 0
    s_nop 0
    buffer_load_dwordx4 v232, s[84:87], s79 offen lds
    s_add_u32 s79, s79, 10240
    s_add_u32 m0, s78, 1024
    s_nop 0
    buffer_load_dwordx4 v233, s[84:87], s79 offen lds
    s_add_u32 s79, s79, 10240
    s_add_u32 m0, s78, 2048
    s_nop 0
    buffer_load_dwordx4 v232, s[84:87], s79 offen lds
    s_add_u32 s79, s79, 10240
    s_add_u32 m0, s78, 3072
    s_nop 0
    buffer_load_dwordx4 v233, s[84:87], s79 offen lds
    v_lshrrev_b32 v5, 2, v3
    v_lshl_add_u32 v6, v4, 3, v5
    v_lshlrev_b32 v6, 7, v6
    v_and_b32 v7, 1, v2
    v_lshl_add_u32 v6, v7, 3, v6
    v_add_u32 v6, s78, v6
    v_and_b32 v5, 2, v5
    v_and_b32 v7, 1, v4
    v_lshl_or_b32 v5, v7, 2, v5
    v_lshrrev_b32 v7, 1, v2
    v_and_b32 v7, 1, v7
    v_add_u32 v1, 0, v7
    v_xor_b32 v1, v1, v5
    v_lshl_add_u32 v234, v1, 4, v6
    v_add_u32 v1, 2, v7
    v_xor_b32 v1, v1, v5
    v_lshl_add_u32 v235, v1, 4, v6
    v_add_u32 v1, 4, v7
    v_xor_b32 v1, v1, v5
    v_lshl_add_u32 v236, v1, 4, v6
    v_add_u32 v1, 6, v7
    v_xor_b32 v1, v1, v5
    v_lshl_add_u32 v237, v1, 4, v6
    s_lshl_b32 s79, s77, 2
    s_add_u32 s79, s79, 0
    s_mul_i32 s78, s79, 52
    s_lshr_b32 s78, s78, 8
    s_mul_i32 s80, s78, 5
    s_sub_u32 s79, s79, s80
    s_mul_i32 s78, s78, 68
    s_add_u32 s78, s78, s76
    s_mul_i32 s78, s78, 5
    s_add_u32 s78, s78, s79
    s_lshl_b32 s78, s78, 10
    s_add_u32 s80, s78, 8912896
    s_lshl_b32 s79, s77, 2
    s_add_u32 s79, s79, 1
    s_mul_i32 s78, s79, 52
    s_lshr_b32 s78, s78, 8
    s_mul_i32 s81, s78, 5
    s_sub_u32 s79, s79, s81
    s_mul_i32 s78, s78, 68
    s_add_u32 s78, s78, s76
    s_mul_i32 s78, s78, 5
    s_add_u32 s78, s78, s79
    s_lshl_b32 s78, s78, 10
    s_add_u32 s81, s78, 8912896
    s_lshl_b32 s79, s77, 2
    s_add_u32 s79, s79, 2
    s_mul_i32 s78, s79, 52
    s_lshr_b32 s78, s78, 8
    s_mul_i32 s82, s78, 5
    s_sub_u32 s79, s79, s82
    s_mul_i32 s78, s78, 68
    s_add_u32 s78, s78, s76
    s_mul_i32 s78, s78, 5
    s_add_u32 s78, s78, s79
    s_lshl_b32 s78, s78, 10
    s_add_u32 s82, s78, 8912896
    s_lshl_b32 s79, s77, 2
    s_add_u32 s79, s79, 3
    s_mul_i32 s78, s79, 52
    s_lshr_b32 s78, s78, 8
    s_mul_i32 s83, s78, 5
    s_sub_u32 s79, s79, s83
    s_mul_i32 s78, s78, 68
    s_add_u32 s78, s78, s76
    s_mul_i32 s78, s78, 5
    s_add_u32 s78, s78, s79
    s_lshl_b32 s78, s78, 10
    s_add_u32 s83, s78, 8912896
    s_and_b32 s53, s8, 3
    s_lshl_b32 s53, s53, 2
    s_add_u32 s54, s53, 0
    s_mul_i32 s52, s54, 52
    s_lshr_b32 s52, s52, 8
    s_mul_i32 s55, s52, 5
    s_sub_u32 s55, s54, s55
    s_lshl_b32 s55, s55, 5
    s_mul_i32 s52, s52, 24192
    s_add_u32 s52, s52, s55
    s_sub_u32 s60, s52, 2688
    s_cmp_ge_u32 s54, 15
    s_cselect_b32 s60, 67968, s60
    s_add_u32 s54, s53, 1
    s_mul_i32 s52, s54, 52
    s_lshr_b32 s52, s52, 8
    s_mul_i32 s55, s52, 5
    s_sub_u32 s55, s54, s55
    s_lshl_b32 s55, s55, 5
    s_mul_i32 s52, s52, 24192
    s_add_u32 s52, s52, s55
    s_sub_u32 s61, s52, 2688
    s_cmp_ge_u32 s54, 15
    s_cselect_b32 s61, 67968, s61
    s_add_u32 s54, s53, 2
    s_mul_i32 s52, s54, 52
    s_lshr_b32 s52, s52, 8
    s_mul_i32 s55, s52, 5
    s_sub_u32 s55, s54, s55
    s_lshl_b32 s55, s55, 5
    s_mul_i32 s52, s52, 24192
    s_add_u32 s52, s52, s55
    s_sub_u32 s62, s52, 2688
    s_cmp_ge_u32 s54, 15
    s_cselect_b32 s62, 67968, s62
    s_add_u32 s54, s53, 3
    s_mul_i32 s52, s54, 52
    s_lshr_b32 s52, s52, 8
    s_mul_i32 s55, s52, 5
    s_sub_u32 s55, s54, s55
    s_lshl_b32 s55, s55, 5
    s_mul_i32 s52, s52, 24192
    s_add_u32 s52, s52, s55
    s_sub_u32 s63, s52, 2688
    s_cmp_ge_u32 s54, 15
    s_cselect_b32 s63, 67968, s63
    s_lshr_b32 s54, s8, 2
    s_lshl_b32 s54, s54, 1
    s_add_u32 s88, s53, s54
    s_add_u32 s89, s88, 1
    s_mul_i32 s52, s88, 52
    s_lshr_b32 s52, s52, 8
    s_mul_i32 s55, s52, 5
    s_sub_u32 s55, s88, s55
    s_lshl_b32 s55, s55, 5
    s_mul_i32 s52, s52, 24192
    s_add_u32 s52, s52, s55
    s_sub_u32 s68, s52, 2688
    s_cmp_ge_u32 s88, 15
    s_cselect_b32 s68, 70656, s68
    s_cmp_lt_u32 s88, 5
    s_cselect_b32 s68, 70656, s68
    s_mul_i32 s52, s89, 52
    s_lshr_b32 s52, s52, 8
    s_mul_i32 s55, s52, 5
    s_sub_u32 s55, s89, s55
    s_lshl_b32 s55, s55, 5
    s_mul_i32 s52, s52, 24192
    s_add_u32 s52, s52, s55
    s_sub_u32 s69, s52, 2688
    s_cmp_ge_u32 s89, 15
    s_cselect_b32 s69, 70656, s69
    s_cmp_lt_u32 s89, 5
    s_cselect_b32 s69, 70656, s69
qkv_nolate:
    s_cmp_lg_u32 s15, 3
    s_cbranch_scc1 qkv_nomid
    ds_read_b64_tr_b16 v[208:209], v234
    ds_read_b64_tr_b16 v[210:211], v234 offset:512
    ds_read_b64_tr_b16 v[212:213], v235
    ds_read_b64_tr_b16 v[214:215], v235 offset:512
    ds_read_b64_tr_b16 v[216:217], v236
    ds_read_b64_tr_b16 v[218:219], v236 offset:512
    ds_read_b64_tr_b16 v[220:221], v237
    ds_read_b64_tr_b16 v[222:223], v237 offset:512
    v_lshlrev_b32 v1, 4, v2
    s_waitcnt lgkmcnt(6)
    buffer_store_dwordx4 v[208:211], v1, s[44:47], s80 offen
    s_waitcnt lgkmcnt(4)
    buffer_store_dwordx4 v[212:215], v1, s[44:47], s81 offen
    s_waitcnt lgkmcnt(2)
    buffer_store_dwordx4 v[216:219], v1, s[44:47], s82 offen
    s_waitcnt lgkmcnt(0)
    buffer_store_dwordx4 v[220:223], v1, s[44:47], s83 offen
qkv_nomid:
    s_add_u32 s15, s15, 1
    s_cmp_lt_u32 s15, 8
    s_cbranch_scc1 qkv_loop
    s_waitcnt vmcnt(4)
    s_barrier
    v_add_u32 v117, s9, v111
    v_add_u32 v118, s9, v113
    v_add_u32 v120, s11, v114
    v_mfma_f32_16x16x32_bf16 v[128:131], v[28:31], v[8:11], v[128:131]
    ds_read_b128 v[44:47], v117 offset:0
    v_mfma_f32_16x16x32_bf16 v[132:135], v[28:31], v[12:15], v[132:135]
    ds_read_b128 v[48:51], v117 offset:2048
    v_mfma_f32_16x16x32_bf16 v[136:139], v[28:31], v[16:19], v[136:139]
    ds_read_b128 v[52:55], v117 offset:4096
    v_mfma_f32_16x16x32_bf16 v[140:143], v[28:31], v[20:23], v[140:143]
    ds_read_b128 v[56:59], v117 offset:6144
    v_mfma_f32_16x16x32_bf16 v[144:147], v[32:35], v[8:11], v[144:147]
    ds_read_b128 v[60:63], v118 offset:0
    v_mfma_f32_16x16x32_bf16 v[148:151], v[32:35], v[12:15], v[148:151]
    ds_read_b64_tr_b16 v[64:65], v120 offset:0
    v_mfma_f32_16x16x32_bf16 v[152:155], v[32:35], v[16:19], v[152:155]
    ds_read_b64_tr_b16 v[66:67], v120 offset:1920
    v_mfma_f32_16x16x32_bf16 v[156:159], v[32:35], v[20:23], v[156:159]
    ds_read_b64_tr_b16 v[68:69], v120 offset:32
    v_mfma_f32_16x16x32_bf16 v[160:163], v[36:39], v[8:11], v[160:163]
    ds_read_b64_tr_b16 v[70:71], v120 offset:1952
    v_mfma_f32_16x16x32_bf16 v[164:167], v[36:39], v[12:15], v[164:167]
    ds_read_b64_tr_b16 v[72:73], v120 offset:64
    v_mfma_f32_16x16x32_bf16 v[168:171], v[36:39], v[16:19], v[168:171]
    ds_read_b64_tr_b16 v[74:75], v120 offset:1984
    v_mfma_f32_16x16x32_bf16 v[172:175], v[36:39], v[20:23], v[172:175]
    ds_read_b64_tr_b16 v[76:77], v120 offset:96
    v_mfma_f32_16x16x32_bf16 v[176:179], v[40:43], v[8:11], v[176:179]
    ds_read_b64_tr_b16 v[78:79], v120 offset:2016
    v_mfma_f32_16x16x32_bf16 v[180:183], v[40:43], v[12:15], v[180:183]
    v_mfma_f32_16x16x32_bf16 v[184:187], v[40:43], v[16:19], v[184:187]
    v_mfma_f32_16x16x32_bf16 v[188:191], v[40:43], v[20:23], v[188:191]
    s_cbranch_vccz qkv_cb_2247_0
    v_mfma_f32_16x16x32_bf16 v[192:195], v[28:31], v[24:27], v[192:195]
    v_mfma_f32_16x16x32_bf16 v[224:227], v[28:31], v[248:251], v[224:227]
    v_mfma_f32_16x16x32_bf16 v[196:199], v[32:35], v[24:27], v[196:199]
    v_mfma_f32_16x16x32_bf16 v[228:231], v[32:35], v[248:251], v[228:231]
    s_branch qkv_cj_2247_0
qkv_cb_2247_0:
    v_mfma_f32_16x16x32_bf16 v[192:195], v[36:39], v[24:27], v[192:195]
    v_mfma_f32_16x16x32_bf16 v[224:227], v[36:39], v[248:251], v[224:227]
    v_mfma_f32_16x16x32_bf16 v[196:199], v[40:43], v[24:27], v[196:199]
    v_mfma_f32_16x16x32_bf16 v[228:231], v[40:43], v[248:251], v[228:231]
qkv_cj_2247_0:
    s_mov_b32 s12, s11
    s_add_u32 s11, s11, 16384
    s_cmp_ge_u32 s11, 120832
    s_cselect_b32 s11, 55296, s11
    s_waitcnt lgkmcnt(0)
    s_waitcnt vmcnt(2)
    s_barrier
    s_sub_u32 s3, s7, 16
    v_add_u32 v245, s3, v0
    v_lshlrev_b32 v244, 4, v245
    buffer_load_dwordx4 v[240:243], v244, s[92:95], 0 offen sc1
    v_add_u32 v117, s10, v110
    v_add_u32 v118, s10, v112
    v_add_u32 v120, s11, v114
    v_mfma_f32_16x16x32_bf16 v[128:131], v[64:67], v[44:47], v[128:131]
    ds_read_b128 v[8:11], v117 offset:0
    v_mfma_f32_16x16x32_bf16 v[132:135], v[64:67], v[48:51], v[132:135]
    ds_read_b128 v[12:15], v117 offset:2048
    v_mfma_f32_16x16x32_bf16 v[136:139], v[64:67], v[52:55], v[136:139]
    ds_read_b128 v[16:19], v117 offset:4096
    v_mfma_f32_16x16x32_bf16 v[140:143], v[64:67], v[56:59], v[140:143]
    ds_read_b128 v[20:23], v117 offset:6144
    v_mfma_f32_16x16x32_bf16 v[144:147], v[68:71], v[44:47], v[144:147]
    ds_read_b128 v[24:27], v118 offset:0
    v_mfma_f32_16x16x32_bf16 v[148:151], v[68:71], v[48:51], v[148:151]
    ds_read_b64_tr_b16 v[28:29], v120 offset:0
    v_mfma_f32_16x16x32_bf16 v[152:155], v[68:71], v[52:55], v[152:155]
    ds_read_b64_tr_b16 v[30:31], v120 offset:1920
    v_mfma_f32_16x16x32_bf16 v[156:159], v[68:71], v[56:59], v[156:159]
    ds_read_b64_tr_b16 v[32:33], v120 offset:32
    v_mfma_f32_16x16x32_bf16 v[160:163], v[72:75], v[44:47], v[160:163]
    ds_read_b64_tr_b16 v[34:35], v120 offset:1952
    v_mfma_f32_16x16x32_bf16 v[164:167], v[72:75], v[48:51], v[164:167]
    ds_read_b64_tr_b16 v[36:37], v120 offset:64
    v_mfma_f32_16x16x32_bf16 v[168:171], v[72:75], v[52:55], v[168:171]
    ds_read_b64_tr_b16 v[38:39], v120 offset:1984
    v_mfma_f32_16x16x32_bf16 v[172:175], v[72:75], v[56:59], v[172:175]
    ds_read_b64_tr_b16 v[40:41], v120 offset:96
    v_mfma_f32_16x16x32_bf16 v[176:179], v[76:79], v[44:47], v[176:179]
    ds_read_b64_tr_b16 v[42:43], v120 offset:2016
    v_mfma_f32_16x16x32_bf16 v[180:183], v[76:79], v[48:51], v[180:183]
    v_mfma_f32_16x16x32_bf16 v[184:187], v[76:79], v[52:55], v[184:187]
    v_mfma_f32_16x16x32_bf16 v[188:191], v[76:79], v[56:59], v[188:191]
    s_cbranch_vccz qkv_cb_2302_1
    v_mfma_f32_16x16x32_bf16 v[192:195], v[64:67], v[60:63], v[192:195]
    v_mfma_f32_16x16x32_bf16 v[224:227], v[64:67], v[248:251], v[224:227]
    v_mfma_f32_16x16x32_bf16 v[196:199], v[68:71], v[60:63], v[196:199]
    v_mfma_f32_16x16x32_bf16 v[228:231], v[68:71], v[248:251], v[228:231]
    s_branch qkv_cj_2302_1
qkv_cb_2302_1:
    v_mfma_f32_16x16x32_bf16 v[192:195], v[72:75], v[60:63], v[192:195]
    v_mfma_f32_16x16x32_bf16 v[224:227], v[72:75], v[248:251], v[224:227]
    v_mfma_f32_16x16x32_bf16 v[196:199], v[76:79], v[60:63], v[196:199]
    v_mfma_f32_16x16x32_bf16 v[228:231], v[76:79], v[248:251], v[228:231]
qkv_cj_2302_1:
    s_mov_b32 s12, s11
    s_add_u32 s11, s11, 16384
    s_cmp_ge_u32 s11, 120832
    s_cselect_b32 s11, 55296, s11
    s_mov_b32 s9, s10
    s_add_u32 s10, s10, 18432
    s_cmp_ge_u32 s10, 55296
    s_cselect_b32 s10, 0, s10
    s_waitcnt lgkmcnt(0)
    s_waitcnt vmcnt(0)
    s_barrier
    v_subrev_u32 v241, s90, v241
    v_subrev_u32 v243, s90, v243
    v_or_b32 v241, v241, v243
    v_lshrrev_b32 v241, 16, v241
    s_mov_b32 s3, 2048
    v_cmp_gt_u32_e64 s[76:77], s3, v245
    v_mov_b32 v243, v242
    v_mov_b32 v242, v240
    v_cndmask_b32_e64 v241, 0, v241, s[76:77]
    v_lshlrev_b32 v244, 3, v0
    v_add_u32 v244, 153600, v244
    s_movk_i32 s3, 144
    v_cmp_gt_u32_e64 s[76:77], s3, v0
    s_and_saveexec_b64 s[78:79], s[76:77]
    ds_write_b64 v244, v[242:243]
    v_cmp_ne_u32_e64 s[76:77], 0, v241
    s_and_b64 exec, exec, s[76:77]
    v_mov_b32 v244, 156416
    v_mov_b32 v245, 1
    ds_write_b32 v244, v245
    s_mov_b64 exec, s[78:79]
    v_add_u32 v117, s9, v111
    v_add_u32 v118, s9, v113
    v_add_u32 v120, s11, v114
    v_mfma_f32_16x16x32_bf16 v[128:131], v[28:31], v[8:11], v[128:131]
    ds_read_b128 v[44:47], v117 offset:0
    v_mfma_f32_16x16x32_bf16 v[132:135], v[28:31], v[12:15], v[132:135]
    ds_read_b128 v[48:51], v117 offset:2048
    v_mfma_f32_16x16x32_bf16 v[136:139], v[28:31], v[16:19], v[136:139]
    ds_read_b128 v[52:55], v117 offset:4096
    v_mfma_f32_16x16x32_bf16 v[140:143], v[28:31], v[20:23], v[140:143]
    ds_read_b128 v[56:59], v117 offset:6144
    v_mfma_f32_16x16x32_bf16 v[144:147], v[32:35], v[8:11], v[144:147]
    ds_read_b128 v[60:63], v118 offset:0
    v_mfma_f32_16x16x32_bf16 v[148:151], v[32:35], v[12:15], v[148:151]
    ds_read_b64_tr_b16 v[64:65], v120 offset:0
    v_mfma_f32_16x16x32_bf16 v[152:155], v[32:35], v[16:19], v[152:155]
    ds_read_b64_tr_b16 v[66:67], v120 offset:1920
    v_mfma_f32_16x16x32_bf16 v[156:159], v[32:35], v[20:23], v[156:159]
    ds_read_b64_tr_b16 v[68:69], v120 offset:32
    v_mfma_f32_16x16x32_bf16 v[160:163], v[36:39], v[8:11], v[160:163]
    ds_read_b64_tr_b16 v[70:71], v120 offset:1952
    v_mfma_f32_16x16x32_bf16 v[164:167], v[36:39], v[12:15], v[164:167]
    ds_read_b64_tr_b16 v[72:73], v120 offset:64
    v_mfma_f32_16x16x32_bf16 v[168:171], v[36:39], v[16:19], v[168:171]
    ds_read_b64_tr_b16 v[74:75], v120 offset:1984
    v_mfma_f32_16x16x32_bf16 v[172:175], v[36:39], v[20:23], v[172:175]
    ds_read_b64_tr_b16 v[76:77], v120 offset:96
    v_mfma_f32_16x16x32_bf16 v[176:179], v[40:43], v[8:11], v[176:179]
    ds_read_b64_tr_b16 v[78:79], v120 offset:2016
    v_mfma_f32_16x16x32_bf16 v[180:183], v[40:43], v[12:15], v[180:183]
    v_mfma_f32_16x16x32_bf16 v[184:187], v[40:43], v[16:19], v[184:187]
    v_mfma_f32_16x16x32_bf16 v[188:191], v[40:43], v[20:23], v[188:191]
    s_cbranch_vccz qkv_cb_2378_0
    v_mfma_f32_16x16x32_bf16 v[192:195], v[28:31], v[24:27], v[192:195]
    v_mfma_f32_16x16x32_bf16 v[224:227], v[28:31], v[248:251], v[224:227]
    v_mfma_f32_16x16x32_bf16 v[196:199], v[32:35], v[24:27], v[196:199]
    v_mfma_f32_16x16x32_bf16 v[228:231], v[32:35], v[248:251], v[228:231]
    s_branch qkv_cj_2378_0
qkv_cb_2378_0:
    v_mfma_f32_16x16x32_bf16 v[192:195], v[36:39], v[24:27], v[192:195]
    v_mfma_f32_16x16x32_bf16 v[224:227], v[36:39], v[248:251], v[224:227]
    v_mfma_f32_16x16x32_bf16 v[196:199], v[40:43], v[24:27], v[196:199]
    v_mfma_f32_16x16x32_bf16 v[228:231], v[40:43], v[248:251], v[228:231]
qkv_cj_2378_0:
    s_mov_b32 s12, s11
    s_add_u32 s11, s11, 16384
    s_cmp_ge_u32 s11, 120832
    s_cselect_b32 s11, 55296, s11
    s_waitcnt lgkmcnt(0)
    s_barrier
    v_mfma_f32_16x16x32_bf16 v[128:131], v[64:67], v[44:47], v[128:131]
    v_mfma_f32_16x16x32_bf16 v[132:135], v[64:67], v[48:51], v[132:135]
    v_mfma_f32_16x16x32_bf16 v[136:139], v[64:67], v[52:55], v[136:139]
    v_mfma_f32_16x16x32_bf16 v[140:143], v[64:67], v[56:59], v[140:143]
    v_mfma_f32_16x16x32_bf16 v[144:147], v[68:71], v[44:47], v[144:147]
    v_mfma_f32_16x16x32_bf16 v[148:151], v[68:71], v[48:51], v[148:151]
    v_mfma_f32_16x16x32_bf16 v[152:155], v[68:71], v[52:55], v[152:155]
    v_mfma_f32_16x16x32_bf16 v[156:159], v[68:71], v[56:59], v[156:159]
    v_mfma_f32_16x16x32_bf16 v[160:163], v[72:75], v[44:47], v[160:163]
    v_mfma_f32_16x16x32_bf16 v[164:167], v[72:75], v[48:51], v[164:167]
    v_mfma_f32_16x16x32_bf16 v[168:171], v[72:75], v[52:55], v[168:171]
    v_mfma_f32_16x16x32_bf16 v[172:175], v[72:75], v[56:59], v[172:175]
    v_mfma_f32_16x16x32_bf16 v[176:179], v[76:79], v[44:47], v[176:179]
    v_mfma_f32_16x16x32_bf16 v[180:183], v[76:79], v[48:51], v[180:183]
    v_mfma_f32_16x16x32_bf16 v[184:187], v[76:79], v[52:55], v[184:187]
    v_mfma_f32_16x16x32_bf16 v[188:191], v[76:79], v[56:59], v[188:191]
    s_cbranch_vccz qkv_cb_2425_1
    v_mfma_f32_16x16x32_bf16 v[192:195], v[64:67], v[60:63], v[192:195]
    v_mfma_f32_16x16x32_bf16 v[224:227], v[64:67], v[248:251], v[224:227]
    v_mfma_f32_16x16x32_bf16 v[196:199], v[68:71], v[60:63], v[196:199]
    v_mfma_f32_16x16x32_bf16 v[228:231], v[68:71], v[248:251], v[228:231]
    s_branch qkv_cj_2425_1
qkv_cb_2425_1:
    v_mfma_f32_16x16x32_bf16 v[192:195], v[72:75], v[60:63], v[192:195]
    v_mfma_f32_16x16x32_bf16 v[224:227], v[72:75], v[248:251], v[224:227]
    v_mfma_f32_16x16x32_bf16 v[196:199], v[76:79], v[60:63], v[196:199]
    v_mfma_f32_16x16x32_bf16 v[228:231], v[76:79], v[248:251], v[228:231]
qkv_cj_2425_1:
    s_waitcnt vmcnt(0)
    s_barrier
    v_lshlrev_b32 v6, 4, v4
    v_add_u32 v6, 154880, v6
    s_lshl_b32 s54, s88, 6
    v_add_u32 v9, s54, v6
    s_lshl_b32 s54, s89, 6
    v_add_u32 v10, s54, v6
    s_mov_b32 exec_lo, 0x00010001
    s_mov_b32 exec_hi, 0x00010001
    ds_write_b128 v9, v[224:227]
    ds_write_b128 v10, v[228:231]
    s_mov_b64 exec, -1
    s_mov_b32 s59, 0
    s_sub_u32 s3, s7, 16
    v_add_u32 v5, s3, v0
    v_lshlrev_b32 v6, 4, v5
    v_lshlrev_b32 v7, 3, v0
    v_add_u32 v7, 153600, v7
    v_mov_b32 v13, 156416
    s_branch qkv_g_check
qkv_g_retry:
    buffer_load_dwordx4 v[8:11], v6, s[92:95], 0 offen sc1
    v_mov_b32 v14, 0
    ds_write_b32 v13, v14
    s_waitcnt vmcnt(0) lgkmcnt(0)
    s_barrier
    v_subrev_u32 v9, s90, v9
    v_subrev_u32 v11, s90, v11
    v_or_b32 v9, v9, v11
    v_lshrrev_b32 v9, 16, v9
    v_cmp_gt_u32 vcc, 144, v0
    s_nop 1
    v_cndmask_b32 v9, 0, v9, vcc
    v_cmp_gt_u32 vcc, 2048, v5
    s_nop 1
    v_cndmask_b32 v9, 0, v9, vcc
    v_mov_b32 v11, v10
    v_mov_b32 v10, v8
    v_cmp_gt_u32 vcc, 144, v0
    s_and_saveexec_b64 s[76:77], vcc
    ds_write_b64 v7, v[10:11]
    s_mov_b64 exec, s[76:77]
    v_cmp_ne_u32 vcc, 0, v9
    s_and_saveexec_b64 s[76:77], vcc
    v_mov_b32 v14, 1
    ds_write_b32 v13, v14
    s_mov_b64 exec, s[76:77]
qkv_g_check:
    s_waitcnt lgkmcnt(0)
    s_barrier
    ds_read_b32 v14, v13
    s_waitcnt lgkmcnt(0)
    v_readfirstlane_b32 s3, v14
    s_nop 3
    s_cmp_eq_u32 s3, 0
    s_cbranch_scc1 qkv_g_done
    s_barrier
    s_add_u32 s59, s59, 1
    s_cmp_lt_u32 s59, 300
    s_cbranch_scc1 qkv_g_retry
    s_mov_b32 s91, s8
    v_mul_u32_u24 v13, 20, v2
qkv_g_fb:
    s_add_u32 s3, s91, s7
    s_sub_u32 s3, s3, 16
    s_mul_i32 s3, s3, 1280
    v_add_u32 v27, s3, v13
    buffer_load_dwordx4 v[8:11], v27, s[40:43], 0 offen
    buffer_load_dword v12, v27, s[40:43], 0 offen offset:16
    s_waitcnt vmcnt(0)
    v_lshlrev_b32 v14, 16, v8
    v_and_b32 v15, 0xffff0000, v8
    v_lshlrev_b32 v16, 16, v9
    v_and_b32 v17, 0xffff0000, v9
    v_lshlrev_b32 v18, 16, v10
    v_and_b32 v19, 0xffff0000, v10
    v_lshlrev_b32 v20, 16, v11
    v_and_b32 v21, 0xffff0000, v11
    v_lshlrev_b32 v22, 16, v12
    v_and_b32 v23, 0xffff0000, v12
    v_add_f32 v24, v14, v15
    v_add_f32 v24, v24, v16
    v_add_f32 v24, v24, v17
    v_add_f32 v24, v24, v18
    v_add_f32 v24, v24, v19
    v_add_f32 v24, v24, v20
    v_add_f32 v24, v24, v21
    v_add_f32 v24, v24, v22
    v_add_f32 v24, v24, v23
    s_nop 1
    v_add_f32_dpp v24, v24, v24 quad_perm:[1,0,3,2] row_mask:0xf bank_mask:0xf
    s_nop 1
    v_add_f32_dpp v24, v24, v24 quad_perm:[2,3,0,1] row_mask:0xf bank_mask:0xf
    s_nop 1
    v_add_f32_dpp v24, v24, v24 row_half_mirror row_mask:0xf bank_mask:0xf
    s_nop 1
    v_add_f32_dpp v24, v24, v24 row_mirror row_mask:0xf bank_mask:0xf
    s_nop 1
    v_readlane_b32 s75, v24, 0
    v_readlane_b32 s76, v24, 16
    v_readlane_b32 s77, v24, 32
    v_readlane_b32 s78, v24, 48
    s_nop 1
    v_mov_b32 v24, s75
    v_add_f32 v24, s76, v24
    v_add_f32 v24, s77, v24
    v_add_f32 v24, s78, v24
    v_mul_f32 v24, 0x3acccccd, v24
    v_sub_f32 v26, v14, v24
    v_mul_f32 v25, v26, v26
    v_sub_f32 v26, v15, v24
    v_fmac_f32 v25, v26, v26
    v_sub_f32 v26, v16, v24
    v_fmac_f32 v25, v26, v26
    v_sub_f32 v26, v17, v24
    v_fmac_f32 v25, v26, v26
    v_sub_f32 v26, v18, v24
    v_fmac_f32 v25, v26, v26
    v_sub_f32 v26, v19, v24
    v_fmac_f32 v25, v26, v26
    v_sub_f32 v26, v20, v24
    v_fmac_f32 v25, v26, v26
    v_sub_f32 v26, v21, v24
    v_fmac_f32 v25, v26, v26
    v_sub_f32 v26, v22, v24
    v_fmac_f32 v25, v26, v26
    v_sub_f32 v26, v23, v24
    v_fmac_f32 v25, v26, v26
    s_nop 1
    v_add_f32_dpp v25, v25, v25 quad_perm:[1,0,3,2] row_mask:0xf bank_mask:0xf
    s_nop 1
    v_add_f32_dpp v25, v25, v25 quad_perm:[2,3,0,1] row_mask:0xf bank_mask:0xf
    s_nop 1
    v_add_f32_dpp v25, v25, v25 row_half_mirror row_mask:0xf bank_mask:0xf
    s_nop 1
    v_add_f32_dpp v25, v25, v25 row_mirror row_mask:0xf bank_mask:0xf
    s_nop 1
    v_readlane_b32 s75, v25, 0
    v_readlane_b32 s76, v25, 16
    v_readlane_b32 s77, v25, 32
    v_readlane_b32 s78, v25, 48
    s_nop 1
    v_mov_b32 v25, s75
    v_add_f32 v25, s76, v25
    v_add_f32 v25, s77, v25
    v_add_f32 v25, s78, v25
    v_mul_f32 v25, 0x3acccccd, v25
    v_cvt_pk_bf16_f32 v26, v24, v25
    v_lshlrev_b32 v24, 16, v26
    v_and_b32 v25, 0xffff0000, v26
    v_add_f32 v25, 0x3727c5ac, v25
    v_cvt_pk_bf16_f32 v25, v25, v25
    v_lshlrev_b32 v25, 16, v25
    v_sqrt_f32 v25, v25
    s_nop 0
    v_cvt_pk_bf16_f32 v25, v25, v25
    v_lshlrev_b32 v25, 16, v25
    v_rcp_f32 v25, v25
    s_nop 0
    s_lshl_b32 s3, s91, 3
    s_add_u32 s3, s3, 153600
    v_mov_b32 v26, s3
    ds_write_b64 v26, v[24:25]
    s_add_u32 s91, s91, 8
    s_cmp_lt_u32 s91, 144
    s_cbranch_scc1 qkv_g_fb
    s_waitcnt lgkmcnt(0)
    s_barrier
qkv_g_done:
    v_lshlrev_b32 v5, 3, v3
    v_add_u32 v5, 153600, v5
    s_lshr_b32 s54, s36, 4
    v_add_u32 v6, s54, v5
    ds_read_b64 v[16:17], v6 offset:0
    ds_read_b64 v[18:19], v6 offset:128
    ds_read_b64 v[20:21], v6 offset:256
    ds_read_b64 v[22:23], v6 offset:384
    ds_read_b64 v[24:25], v5
    v_lshlrev_b32 v6, 4, v4
    v_add_u32 v6, 154880, v6
    s_and_b32 s53, s8, 3
    s_lshl_b32 s54, s53, 8
    v_add_u32 v7, s54, v6
    ds_read_b128 v[32:35], v7 offset:0
    ds_read_b128 v[36:39], v7 offset:64
    ds_read_b128 v[40:43], v7 offset:128
    ds_read_b128 v[44:47], v7 offset:192
    v_mul_u32_u24 v5, 168, v3
    v_lshl_add_u32 v5, v4, 3, v5
    s_lshr_b32 s54, s36, 11
    s_mul_i32 s54, s54, 2688
    v_add_u32 v26, s54, v5
    s_waitcnt lgkmcnt(0)
    v_xor_b32 v16, 0x80000000, v16
    v_xor_b32 v18, 0x80000000, v18
    v_xor_b32 v20, 0x80000000, v20
    v_xor_b32 v22, 0x80000000, v22
    v_xor_b32 v24, 0x80000000, v24
    v_add_u32 v7, s60, v26
    v_pk_fma_f32 v[128:129], v[32:33], v[16:17], v[128:129] op_sel_hi:[1,0,1]
    v_pk_fma_f32 v[130:131], v[34:35], v[16:17], v[130:131] op_sel_hi:[1,0,1]
    v_pk_mul_f32 v[128:129], v[128:129], v[16:17] op_sel:[0,1] op_sel_hi:[1,1]
    v_pk_mul_f32 v[130:131], v[130:131], v[16:17] op_sel:[0,1] op_sel_hi:[1,1]
    v_cvt_pk_bf16_f32 v128, v128, v129
    v_cvt_pk_bf16_f32 v129, v130, v131
    ds_write_b64 v7, v[128:129] offset:0
    v_pk_fma_f32 v[132:133], v[32:33], v[18:19], v[132:133] op_sel_hi:[1,0,1]
    v_pk_fma_f32 v[134:135], v[34:35], v[18:19], v[134:135] op_sel_hi:[1,0,1]
    v_pk_mul_f32 v[132:133], v[132:133], v[18:19] op_sel:[0,1] op_sel_hi:[1,1]
    v_pk_mul_f32 v[134:135], v[134:135], v[18:19] op_sel:[0,1] op_sel_hi:[1,1]
    v_cvt_pk_bf16_f32 v132, v132, v133
    v_cvt_pk_bf16_f32 v133, v134, v135
    ds_write_b64 v7, v[132:133] offset:2688
    v_pk_fma_f32 v[136:137], v[32:33], v[20:21], v[136:137] op_sel_hi:[1,0,1]
    v_pk_fma_f32 v[138:139], v[34:35], v[20:21], v[138:139] op_sel_hi:[1,0,1]
    v_pk_mul_f32 v[136:137], v[136:137], v[20:21] op_sel:[0,1] op_sel_hi:[1,1]
    v_pk_mul_f32 v[138:139], v[138:139], v[20:21] op_sel:[0,1] op_sel_hi:[1,1]
    v_cvt_pk_bf16_f32 v136, v136, v137
    v_cvt_pk_bf16_f32 v137, v138, v139
    ds_write_b64 v7, v[136:137] offset:5376
    v_pk_fma_f32 v[140:141], v[32:33], v[22:23], v[140:141] op_sel_hi:[1,0,1]
    v_pk_fma_f32 v[142:143], v[34:35], v[22:23], v[142:143] op_sel_hi:[1,0,1]
    v_pk_mul_f32 v[140:141], v[140:141], v[22:23] op_sel:[0,1] op_sel_hi:[1,1]
    v_pk_mul_f32 v[142:143], v[142:143], v[22:23] op_sel:[0,1] op_sel_hi:[1,1]
    v_cvt_pk_bf16_f32 v140, v140, v141
    v_cvt_pk_bf16_f32 v141, v142, v143
    ds_write_b64 v7, v[140:141] offset:8064
    v_add_u32 v7, s61, v26
    v_pk_fma_f32 v[144:145], v[36:37], v[16:17], v[144:145] op_sel_hi:[1,0,1]
    v_pk_fma_f32 v[146:147], v[38:39], v[16:17], v[146:147] op_sel_hi:[1,0,1]
    v_pk_mul_f32 v[144:145], v[144:145], v[16:17] op_sel:[0,1] op_sel_hi:[1,1]
    v_pk_mul_f32 v[146:147], v[146:147], v[16:17] op_sel:[0,1] op_sel_hi:[1,1]
    v_cvt_pk_bf16_f32 v144, v144, v145
    v_cvt_pk_bf16_f32 v145, v146, v147
    ds_write_b64 v7, v[144:145] offset:0
    v_pk_fma_f32 v[148:149], v[36:37], v[18:19], v[148:149] op_sel_hi:[1,0,1]
    v_pk_fma_f32 v[150:151], v[38:39], v[18:19], v[150:151] op_sel_hi:[1,0,1]
    v_pk_mul_f32 v[148:149], v[148:149], v[18:19] op_sel:[0,1] op_sel_hi:[1,1]
    v_pk_mul_f32 v[150:151], v[150:151], v[18:19] op_sel:[0,1] op_sel_hi:[1,1]
    v_cvt_pk_bf16_f32 v148, v148, v149
    v_cvt_pk_bf16_f32 v149, v150, v151
    ds_write_b64 v7, v[148:149] offset:2688
    v_pk_fma_f32 v[152:153], v[36:37], v[20:21], v[152:153] op_sel_hi:[1,0,1]
    v_pk_fma_f32 v[154:155], v[38:39], v[20:21], v[154:155] op_sel_hi:[1,0,1]
    v_pk_mul_f32 v[152:153], v[152:153], v[20:21] op_sel:[0,1] op_sel_hi:[1,1]
    v_pk_mul_f32 v[154:155], v[154:155], v[20:21] op_sel:[0,1] op_sel_hi:[1,1]
    v_cvt_pk_bf16_f32 v152, v152, v153
    v_cvt_pk_bf16_f32 v153, v154, v155
    ds_write_b64 v7, v[152:153] offset:5376
    v_pk_fma_f32 v[156:157], v[36:37], v[22:23], v[156:157] op_sel_hi:[1,0,1]
    v_pk_fma_f32 v[158:159], v[38:39], v[22:23], v[158:159] op_sel_hi:[1,0,1]
    v_pk_mul_f32 v[156:157], v[156:157], v[22:23] op_sel:[0,1] op_sel_hi:[1,1]
    v_pk_mul_f32 v[158:159], v[158:159], v[22:23] op_sel:[0,1] op_sel_hi:[1,1]
    v_cvt_pk_bf16_f32 v156, v156, v157
    v_cvt_pk_bf16_f32 v157, v158, v159
    ds_write_b64 v7, v[156:157] offset:8064
    v_add_u32 v7, s62, v26
    v_pk_fma_f32 v[160:161], v[40:41], v[16:17], v[160:161] op_sel_hi:[1,0,1]
    v_pk_fma_f32 v[162:163], v[42:43], v[16:17], v[162:163] op_sel_hi:[1,0,1]
    v_pk_mul_f32 v[160:161], v[160:161], v[16:17] op_sel:[0,1] op_sel_hi:[1,1]
    v_pk_mul_f32 v[162:163], v[162:163], v[16:17] op_sel:[0,1] op_sel_hi:[1,1]
    v_cvt_pk_bf16_f32 v160, v160, v161
    v_cvt_pk_bf16_f32 v161, v162, v163
    ds_write_b64 v7, v[160:161] offset:0
    v_pk_fma_f32 v[164:165], v[40:41], v[18:19], v[164:165] op_sel_hi:[1,0,1]
    v_pk_fma_f32 v[166:167], v[42:43], v[18:19], v[166:167] op_sel_hi:[1,0,1]
    v_pk_mul_f32 v[164:165], v[164:165], v[18:19] op_sel:[0,1] op_sel_hi:[1,1]
    v_pk_mul_f32 v[166:167], v[166:167], v[18:19] op_sel:[0,1] op_sel_hi:[1,1]
    v_cvt_pk_bf16_f32 v164, v164, v165
    v_cvt_pk_bf16_f32 v165, v166, v167
    ds_write_b64 v7, v[164:165] offset:2688
    v_pk_fma_f32 v[168:169], v[40:41], v[20:21], v[168:169] op_sel_hi:[1,0,1]
    v_pk_fma_f32 v[170:171], v[42:43], v[20:21], v[170:171] op_sel_hi:[1,0,1]
    v_pk_mul_f32 v[168:169], v[168:169], v[20:21] op_sel:[0,1] op_sel_hi:[1,1]
    v_pk_mul_f32 v[170:171], v[170:171], v[20:21] op_sel:[0,1] op_sel_hi:[1,1]
    v_cvt_pk_bf16_f32 v168, v168, v169
    v_cvt_pk_bf16_f32 v169, v170, v171
    ds_write_b64 v7, v[168:169] offset:5376
    v_pk_fma_f32 v[172:173], v[40:41], v[22:23], v[172:173] op_sel_hi:[1,0,1]
    v_pk_fma_f32 v[174:175], v[42:43], v[22:23], v[174:175] op_sel_hi:[1,0,1]
    v_pk_mul_f32 v[172:173], v[172:173], v[22:23] op_sel:[0,1] op_sel_hi:[1,1]
    v_pk_mul_f32 v[174:175], v[174:175], v[22:23] op_sel:[0,1] op_sel_hi:[1,1]
    v_cvt_pk_bf16_f32 v172, v172, v173
    v_cvt_pk_bf16_f32 v173, v174, v175
    ds_write_b64 v7, v[172:173] offset:8064
    v_add_u32 v7, s63, v26
    v_pk_fma_f32 v[176:177], v[44:45], v[16:17], v[176:177] op_sel_hi:[1,0,1]
    v_pk_fma_f32 v[178:179], v[46:47], v[16:17], v[178:179] op_sel_hi:[1,0,1]
    v_pk_mul_f32 v[176:177], v[176:177], v[16:17] op_sel:[0,1] op_sel_hi:[1,1]
    v_pk_mul_f32 v[178:179], v[178:179], v[16:17] op_sel:[0,1] op_sel_hi:[1,1]
    v_cvt_pk_bf16_f32 v176, v176, v177
    v_cvt_pk_bf16_f32 v177, v178, v179
    ds_write_b64 v7, v[176:177] offset:0
    v_pk_fma_f32 v[180:181], v[44:45], v[18:19], v[180:181] op_sel_hi:[1,0,1]
    v_pk_fma_f32 v[182:183], v[46:47], v[18:19], v[182:183] op_sel_hi:[1,0,1]
    v_pk_mul_f32 v[180:181], v[180:181], v[18:19] op_sel:[0,1] op_sel_hi:[1,1]
    v_pk_mul_f32 v[182:183], v[182:183], v[18:19] op_sel:[0,1] op_sel_hi:[1,1]
    v_cvt_pk_bf16_f32 v180, v180, v181
    v_cvt_pk_bf16_f32 v181, v182, v183
    ds_write_b64 v7, v[180:181] offset:2688
    v_pk_fma_f32 v[184:185], v[44:45], v[20:21], v[184:185] op_sel_hi:[1,0,1]
    v_pk_fma_f32 v[186:187], v[46:47], v[20:21], v[186:187] op_sel_hi:[1,0,1]
    v_pk_mul_f32 v[184:185], v[184:185], v[20:21] op_sel:[0,1] op_sel_hi:[1,1]
    v_pk_mul_f32 v[186:187], v[186:187], v[20:21] op_sel:[0,1] op_sel_hi:[1,1]
    v_cvt_pk_bf16_f32 v184, v184, v185
    v_cvt_pk_bf16_f32 v185, v186, v187
    ds_write_b64 v7, v[184:185] offset:5376
    v_pk_fma_f32 v[188:189], v[44:45], v[22:23], v[188:189] op_sel_hi:[1,0,1]
    v_pk_fma_f32 v[190:191], v[46:47], v[22:23], v[190:191] op_sel_hi:[1,0,1]
    v_pk_mul_f32 v[188:189], v[188:189], v[22:23] op_sel:[0,1] op_sel_hi:[1,1]
    v_pk_mul_f32 v[190:191], v[190:191], v[22:23] op_sel:[0,1] op_sel_hi:[1,1]
    v_cvt_pk_bf16_f32 v188, v188, v189
    v_cvt_pk_bf16_f32 v189, v190, v191
    ds_write_b64 v7, v[188:189] offset:8064
    v_pk_fma_f32 v[192:193], v[224:225], v[24:25], v[192:193] op_sel_hi:[1,0,1]
    v_pk_fma_f32 v[194:195], v[226:227], v[24:25], v[194:195] op_sel_hi:[1,0,1]
    v_pk_mul_f32 v[192:193], v[192:193], v[24:25] op_sel:[0,1] op_sel_hi:[1,1]
    v_pk_mul_f32 v[194:195], v[194:195], v[24:25] op_sel:[0,1] op_sel_hi:[1,1]
    v_cvt_pk_bf16_f32 v192, v192, v193
    v_cvt_pk_bf16_f32 v193, v194, v195
    v_add_u32 v7, s68, v5
    ds_write_b64 v7, v[192:193]
    v_pk_fma_f32 v[196:197], v[228:229], v[24:25], v[196:197] op_sel_hi:[1,0,1]
    v_pk_fma_f32 v[198:199], v[230:231], v[24:25], v[198:199] op_sel_hi:[1,0,1]
    v_pk_mul_f32 v[196:197], v[196:197], v[24:25] op_sel:[0,1] op_sel_hi:[1,1]
    v_pk_mul_f32 v[198:199], v[198:199], v[24:25] op_sel:[0,1] op_sel_hi:[1,1]
    v_cvt_pk_bf16_f32 v196, v196, v197
    v_cvt_pk_bf16_f32 v197, v198, v199
    v_add_u32 v7, s69, v5
    ds_write_b64 v7, v[196:197]
    s_waitcnt lgkmcnt(0)
    s_barrier
    s_and_b32 s52, s8, 1
    s_lshl_b32 s52, s52, 6
    v_add_u32 v5, s52, v2
    v_add_u32 v6, s7, v5
    v_mul_u32_u24 v5, 168, v5
    s_lshr_b32 s53, s8, 1
    s_mul_i32 s54, s53, 40
    v_add_u32 v5, s54, v5
    ds_read_b64 v[8:9], v5 offset:0
    ds_read_b64 v[10:11], v5 offset:8
    ds_read_b64 v[12:13], v5 offset:16
    ds_read_b64 v[14:15], v5 offset:24
    ds_read_b64 v[16:17], v5 offset:32
    ds_read_b64 v[20:21], v5 offset:24192
    ds_read_b64 v[22:23], v5 offset:24200
    ds_read_b64 v[24:25], v5 offset:24208
    ds_read_b64 v[26:27], v5 offset:24216
    ds_read_b64 v[28:29], v5 offset:24224
    ds_read_b64 v[30:31], v5 offset:23856
    ds_read_b64 v[32:33], v5 offset:23864
    ds_read_b64 v[34:35], v5 offset:23872
    ds_read_b64 v[36:37], v5 offset:23880
    ds_read_b64 v[38:39], v5 offset:23888
    ds_read_b64 v[40:41], v5 offset:23520
    ds_read_b64 v[42:43], v5 offset:23528
    ds_read_b64 v[44:45], v5 offset:23536
    ds_read_b64 v[46:47], v5 offset:23544
    ds_read_b64 v[48:49], v5 offset:23552
    ds_read_b64 v[50:51], v5 offset:23184
    ds_read_b64 v[52:53], v5 offset:23192
    ds_read_b64 v[54:55], v5 offset:23200
    ds_read_b64 v[56:57], v5 offset:23208
    ds_read_b64 v[58:59], v5 offset:23216
    ds_read_b64 v[60:61], v5 offset:22848
    ds_read_b64 v[62:63], v5 offset:22856
    ds_read_b64 v[64:65], v5 offset:22864
    ds_read_b64 v[66:67], v5 offset:22872
    ds_read_b64 v[68:69], v5 offset:22880
    ds_read_b64 v[70:71], v5 offset:22512
    ds_read_b64 v[72:73], v5 offset:22520
    ds_read_b64 v[74:75], v5 offset:22528
    ds_read_b64 v[76:77], v5 offset:22536
    ds_read_b64 v[78:79], v5 offset:22544
    ds_read_b64 v[80:81], v5 offset:22176
    ds_read_b64 v[82:83], v5 offset:22184
    ds_read_b64 v[84:85], v5 offset:22192
    ds_read_b64 v[86:87], v5 offset:22200
    ds_read_b64 v[88:89], v5 offset:22208
    ds_read_b64 v[90:91], v5 offset:21840
    ds_read_b64 v[92:93], v5 offset:21848
    ds_read_b64 v[94:95], v5 offset:21856
    ds_read_b64 v[96:97], v5 offset:21864
    ds_read_b64 v[98:99], v5 offset:21872
    s_mov_b32 s72, 0x3e64f92e
    s_mov_b32 s73, 0x3ea52b5c
    s_mov_b32 s70, 0x05040100
    s_mov_b32 s71, 0x07060302
    s_waitcnt lgkmcnt(0)
    v_dot2_f32_bf16 v100, v8, v20, 0
    v_dot2_f32_bf16 v101, v8, v30, 0
    v_dot2_f32_bf16 v102, v8, v40, 0
    v_dot2_f32_bf16 v103, v8, v50, 0
    v_dot2_f32_bf16 v104, v8, v60, 0
    v_dot2_f32_bf16 v105, v8, v70, 0
    v_dot2_f32_bf16 v106, v8, v80, 0
    v_dot2_f32_bf16 v107, v8, v90, 0
    v_dot2_f32_bf16 v100, v9, v21, v100
    v_dot2_f32_bf16 v101, v9, v31, v101
    v_dot2_f32_bf16 v102, v9, v41, v102
    v_dot2_f32_bf16 v103, v9, v51, v103
    v_dot2_f32_bf16 v104, v9, v61, v104
    v_dot2_f32_bf16 v105, v9, v71, v105
    v_dot2_f32_bf16 v106, v9, v81, v106
    v_dot2_f32_bf16 v107, v9, v91, v107
    v_dot2_f32_bf16 v100, v10, v22, v100
    v_dot2_f32_bf16 v101, v10, v32, v101
    v_dot2_f32_bf16 v102, v10, v42, v102
    v_dot2_f32_bf16 v103, v10, v52, v103
    v_dot2_f32_bf16 v104, v10, v62, v104
    v_dot2_f32_bf16 v105, v10, v72, v105
    v_dot2_f32_bf16 v106, v10, v82, v106
    v_dot2_f32_bf16 v107, v10, v92, v107
    v_dot2_f32_bf16 v100, v11, v23, v100
    v_dot2_f32_bf16 v101, v11, v33, v101
    v_dot2_f32_bf16 v102, v11, v43, v102
    v_dot2_f32_bf16 v103, v11, v53, v103
    v_dot2_f32_bf16 v104, v11, v63, v104
    v_dot2_f32_bf16 v105, v11, v73, v105
    v_dot2_f32_bf16 v106, v11, v83, v106
    v_dot2_f32_bf16 v107, v11, v93, v107
    v_dot2_f32_bf16 v100, v12, v24, v100
    v_dot2_f32_bf16 v101, v12, v34, v101
    v_dot2_f32_bf16 v102, v12, v44, v102
    v_dot2_f32_bf16 v103, v12, v54, v103
    v_dot2_f32_bf16 v104, v12, v64, v104
    v_dot2_f32_bf16 v105, v12, v74, v105
    v_dot2_f32_bf16 v106, v12, v84, v106
    v_dot2_f32_bf16 v107, v12, v94, v107
    v_dot2_f32_bf16 v100, v13, v25, v100
    v_dot2_f32_bf16 v101, v13, v35, v101
    v_dot2_f32_bf16 v102, v13, v45, v102
    v_dot2_f32_bf16 v103, v13, v55, v103
    v_dot2_f32_bf16 v104, v13, v65, v104
    v_dot2_f32_bf16 v105, v13, v75, v105
    v_dot2_f32_bf16 v106, v13, v85, v106
    v_dot2_f32_bf16 v107, v13, v95, v107
    v_dot2_f32_bf16 v100, v14, v26, v100
    v_dot2_f32_bf16 v101, v14, v36, v101
    v_dot2_f32_bf16 v102, v14, v46, v102
    v_dot2_f32_bf16 v103, v14, v56, v103
    v_dot2_f32_bf16 v104, v14, v66, v104
    v_dot2_f32_bf16 v105, v14, v76, v105
    v_dot2_f32_bf16 v106, v14, v86, v106
    v_dot2_f32_bf16 v107, v14, v96, v107
    v_dot2_f32_bf16 v100, v15, v27, v100
    v_dot2_f32_bf16 v101, v15, v37, v101
    v_dot2_f32_bf16 v102, v15, v47, v102
    v_dot2_f32_bf16 v103, v15, v57, v103
    v_dot2_f32_bf16 v104, v15, v67, v104
    v_dot2_f32_bf16 v105, v15, v77, v105
    v_dot2_f32_bf16 v106, v15, v87, v106
    v_dot2_f32_bf16 v107, v15, v97, v107
    v_dot2_f32_bf16 v100, v16, v28, v100
    v_dot2_f32_bf16 v101, v16, v38, v101
    v_dot2_f32_bf16 v102, v16, v48, v102
    v_dot2_f32_bf16 v103, v16, v58, v103
    v_dot2_f32_bf16 v104, v16, v68, v104
    v_dot2_f32_bf16 v105, v16, v78, v105
    v_dot2_f32_bf16 v106, v16, v88, v106
    v_dot2_f32_bf16 v107, v16, v98, v107
    v_dot2_f32_bf16 v100, v17, v29, v100
    v_dot2_f32_bf16 v101, v17, v39, v101
    v_dot2_f32_bf16 v102, v17, v49, v102
    v_dot2_f32_bf16 v103, v17, v59, v103
    v_dot2_f32_bf16 v104, v17, v69, v104
    v_dot2_f32_bf16 v105, v17, v79, v105
    v_dot2_f32_bf16 v106, v17, v89, v106
    v_dot2_f32_bf16 v107, v17, v99, v107
    s_nop 3
    ds_read_b64 v[20:21], v5 offset:48384
    ds_read_b64 v[22:23], v5 offset:48392
    ds_read_b64 v[24:25], v5 offset:48400
    ds_read_b64 v[26:27], v5 offset:48408
    ds_read_b64 v[28:29], v5 offset:48416
    ds_read_b64 v[30:31], v5 offset:48048
    ds_read_b64 v[32:33], v5 offset:48056
    ds_read_b64 v[34:35], v5 offset:48064
    ds_read_b64 v[36:37], v5 offset:48072
    ds_read_b64 v[38:39], v5 offset:48080
    ds_read_b64 v[40:41], v5 offset:47712
    ds_read_b64 v[42:43], v5 offset:47720
    ds_read_b64 v[44:45], v5 offset:47728
    ds_read_b64 v[46:47], v5 offset:47736
    ds_read_b64 v[48:49], v5 offset:47744
    ds_read_b64 v[50:51], v5 offset:47376
    ds_read_b64 v[52:53], v5 offset:47384
    ds_read_b64 v[54:55], v5 offset:47392
    ds_read_b64 v[56:57], v5 offset:47400
    ds_read_b64 v[58:59], v5 offset:47408
    ds_read_b64 v[60:61], v5 offset:47040
    ds_read_b64 v[62:63], v5 offset:47048
    ds_read_b64 v[64:65], v5 offset:47056
    ds_read_b64 v[66:67], v5 offset:47064
    ds_read_b64 v[68:69], v5 offset:47072
    ds_read_b64 v[70:71], v5 offset:46704
    ds_read_b64 v[72:73], v5 offset:46712
    ds_read_b64 v[74:75], v5 offset:46720
    ds_read_b64 v[76:77], v5 offset:46728
    ds_read_b64 v[78:79], v5 offset:46736
    ds_read_b64 v[80:81], v5 offset:46368
    ds_read_b64 v[82:83], v5 offset:46376
    ds_read_b64 v[84:85], v5 offset:46384
    ds_read_b64 v[86:87], v5 offset:46392
    ds_read_b64 v[88:89], v5 offset:46400
    ds_read_b64 v[90:91], v5 offset:46032
    ds_read_b64 v[92:93], v5 offset:46040
    ds_read_b64 v[94:95], v5 offset:46048
    ds_read_b64 v[96:97], v5 offset:46056
    ds_read_b64 v[98:99], v5 offset:46064
    s_cmp_lg_u32 s5, 0
    s_cbranch_scc1 qkv_nomask
    v_mov_b32 v7, 0xcf8547b1
    v_cmp_le_u32 vcc, 2, v6
    s_nop 1
    v_cndmask_b32 v101, v7, v101, vcc
    v_cmp_le_u32 vcc, 4, v6
    s_nop 1
    v_cndmask_b32 v102, v7, v102, vcc
    v_cmp_le_u32 vcc, 6, v6
    s_nop 1
    v_cndmask_b32 v103, v7, v103, vcc
    v_cmp_le_u32 vcc, 8, v6
    s_nop 1
    v_cndmask_b32 v104, v7, v104, vcc
    v_cmp_le_u32 vcc, 10, v6
    s_nop 1
    v_cndmask_b32 v105, v7, v105, vcc
    v_cmp_le_u32 vcc, 12, v6
    s_nop 1
    v_cndmask_b32 v106, v7, v106, vcc
    v_cmp_le_u32 vcc, 14, v6
    s_nop 1
    v_cndmask_b32 v107, v7, v107, vcc
qkv_nomask:
    v_max3_f32 v7, v100, v101, v102
    v_max3_f32 v7, v7, v103, v104
    v_max3_f32 v7, v7, v105, v106
    v_max_f32 v7, v7, v107
    v_sub_f32 v100, v100, v7
    v_mul_f32 v100, s73, v100
    v_sub_f32 v101, v101, v7
    v_mul_f32 v101, s73, v101
    v_sub_f32 v102, v102, v7
    v_mul_f32 v102, s73, v102
    v_sub_f32 v103, v103, v7
    v_mul_f32 v103, s73, v103
    v_sub_f32 v104, v104, v7
    v_mul_f32 v104, s73, v104
    v_sub_f32 v105, v105, v7
    v_mul_f32 v105, s73, v105
    v_sub_f32 v106, v106, v7
    v_mul_f32 v106, s73, v106
    v_sub_f32 v107, v107, v7
    v_mul_f32 v107, s73, v107
    v_exp_f32 v100, v100
    v_exp_f32 v101, v101
    v_exp_f32 v102, v102
    v_exp_f32 v103, v103
    v_exp_f32 v104, v104
    v_exp_f32 v105, v105
    v_exp_f32 v106, v106
    v_exp_f32 v107, v107
    s_nop 0
    v_add_f32 v7, v100, v101
    v_add_f32 v7, v7, v102
    v_add_f32 v7, v7, v103
    v_add_f32 v7, v7, v104
    v_add_f32 v7, v7, v105
    v_add_f32 v7, v7, v106
    v_add_f32 v7, v7, v107
    v_rcp_f32 v7, v7
    s_nop 0
    v_mul_f32 v100, v100, v7
    v_mul_f32 v101, v101, v7
    v_mul_f32 v102, v102, v7
    v_mul_f32 v103, v103, v7
    v_mul_f32 v104, v104, v7
    v_mul_f32 v105, v105, v7
    v_mul_f32 v106, v106, v7
    v_mul_f32 v107, v107, v7
    v_cvt_pk_bf16_f32 v100, v100, v101
    v_cvt_pk_bf16_f32 v101, v102, v103
    v_cvt_pk_bf16_f32 v102, v104, v105
    v_cvt_pk_bf16_f32 v103, v106, v107
    s_waitcnt lgkmcnt(0)
    v_perm_b32 v130, v30, v20, s70
    v_perm_b32 v131, v30, v20, s71
    v_dot2_f32_bf16 v110, v130, v100, 0
    v_dot2_f32_bf16 v111, v131, v100, 0
    v_perm_b32 v132, v31, v21, s70
    v_perm_b32 v133, v31, v21, s71
    v_dot2_f32_bf16 v112, v132, v100, 0
    v_dot2_f32_bf16 v113, v133, v100, 0
    v_perm_b32 v134, v32, v22, s70
    v_perm_b32 v135, v32, v22, s71
    v_dot2_f32_bf16 v114, v134, v100, 0
    v_dot2_f32_bf16 v115, v135, v100, 0
    v_perm_b32 v136, v33, v23, s70
    v_perm_b32 v137, v33, v23, s71
    v_dot2_f32_bf16 v116, v136, v100, 0
    v_dot2_f32_bf16 v117, v137, v100, 0
    v_perm_b32 v130, v34, v24, s70
    v_perm_b32 v131, v34, v24, s71
    v_dot2_f32_bf16 v118, v130, v100, 0
    v_dot2_f32_bf16 v119, v131, v100, 0
    v_perm_b32 v132, v35, v25, s70
    v_perm_b32 v133, v35, v25, s71
    v_dot2_f32_bf16 v120, v132, v100, 0
    v_dot2_f32_bf16 v121, v133, v100, 0
    v_perm_b32 v134, v36, v26, s70
    v_perm_b32 v135, v36, v26, s71
    v_dot2_f32_bf16 v122, v134, v100, 0
    v_dot2_f32_bf16 v123, v135, v100, 0
    v_perm_b32 v136, v37, v27, s70
    v_perm_b32 v137, v37, v27, s71
    v_dot2_f32_bf16 v124, v136, v100, 0
    v_dot2_f32_bf16 v125, v137, v100, 0
    v_perm_b32 v130, v38, v28, s70
    v_perm_b32 v131, v38, v28, s71
    v_dot2_f32_bf16 v126, v130, v100, 0
    v_dot2_f32_bf16 v127, v131, v100, 0
    v_perm_b32 v132, v39, v29, s70
    v_perm_b32 v133, v39, v29, s71
    v_dot2_f32_bf16 v128, v132, v100, 0
    v_dot2_f32_bf16 v129, v133, v100, 0
    v_perm_b32 v130, v50, v40, s70
    v_perm_b32 v131, v50, v40, s71
    v_dot2_f32_bf16 v110, v130, v101, v110
    v_dot2_f32_bf16 v111, v131, v101, v111
    v_perm_b32 v132, v51, v41, s70
    v_perm_b32 v133, v51, v41, s71
    v_dot2_f32_bf16 v112, v132, v101, v112
    v_dot2_f32_bf16 v113, v133, v101, v113
    v_perm_b32 v134, v52, v42, s70
    v_perm_b32 v135, v52, v42, s71
    v_dot2_f32_bf16 v114, v134, v101, v114
    v_dot2_f32_bf16 v115, v135, v101, v115
    v_perm_b32 v136, v53, v43, s70
    v_perm_b32 v137, v53, v43, s71
    v_dot2_f32_bf16 v116, v136, v101, v116
    v_dot2_f32_bf16 v117, v137, v101, v117
    v_perm_b32 v130, v54, v44, s70
    v_perm_b32 v131, v54, v44, s71
    v_dot2_f32_bf16 v118, v130, v101, v118
    v_dot2_f32_bf16 v119, v131, v101, v119
    v_perm_b32 v132, v55, v45, s70
    v_perm_b32 v133, v55, v45, s71
    v_dot2_f32_bf16 v120, v132, v101, v120
    v_dot2_f32_bf16 v121, v133, v101, v121
    v_perm_b32 v134, v56, v46, s70
    v_perm_b32 v135, v56, v46, s71
    v_dot2_f32_bf16 v122, v134, v101, v122
    v_dot2_f32_bf16 v123, v135, v101, v123
    v_perm_b32 v136, v57, v47, s70
    v_perm_b32 v137, v57, v47, s71
    v_dot2_f32_bf16 v124, v136, v101, v124
    v_dot2_f32_bf16 v125, v137, v101, v125
    v_perm_b32 v130, v58, v48, s70
    v_perm_b32 v131, v58, v48, s71
    v_dot2_f32_bf16 v126, v130, v101, v126
    v_dot2_f32_bf16 v127, v131, v101, v127
    v_perm_b32 v132, v59, v49, s70
    v_perm_b32 v133, v59, v49, s71
    v_dot2_f32_bf16 v128, v132, v101, v128
    v_dot2_f32_bf16 v129, v133, v101, v129
    v_perm_b32 v130, v70, v60, s70
    v_perm_b32 v131, v70, v60, s71
    v_dot2_f32_bf16 v110, v130, v102, v110
    v_dot2_f32_bf16 v111, v131, v102, v111
    v_perm_b32 v132, v71, v61, s70
    v_perm_b32 v133, v71, v61, s71
    v_dot2_f32_bf16 v112, v132, v102, v112
    v_dot2_f32_bf16 v113, v133, v102, v113
    v_perm_b32 v134, v72, v62, s70
    v_perm_b32 v135, v72, v62, s71
    v_dot2_f32_bf16 v114, v134, v102, v114
    v_dot2_f32_bf16 v115, v135, v102, v115
    v_perm_b32 v136, v73, v63, s70
    v_perm_b32 v137, v73, v63, s71
    v_dot2_f32_bf16 v116, v136, v102, v116
    v_dot2_f32_bf16 v117, v137, v102, v117
    v_perm_b32 v130, v74, v64, s70
    v_perm_b32 v131, v74, v64, s71
    v_dot2_f32_bf16 v118, v130, v102, v118
    v_dot2_f32_bf16 v119, v131, v102, v119
    v_perm_b32 v132, v75, v65, s70
    v_perm_b32 v133, v75, v65, s71
    v_dot2_f32_bf16 v120, v132, v102, v120
    v_dot2_f32_bf16 v121, v133, v102, v121
    v_perm_b32 v134, v76, v66, s70
    v_perm_b32 v135, v76, v66, s71
    v_dot2_f32_bf16 v122, v134, v102, v122
    v_dot2_f32_bf16 v123, v135, v102, v123
    v_perm_b32 v136, v77, v67, s70
    v_perm_b32 v137, v77, v67, s71
    v_dot2_f32_bf16 v124, v136, v102, v124
    v_dot2_f32_bf16 v125, v137, v102, v125
    v_perm_b32 v130, v78, v68, s70
    v_perm_b32 v131, v78, v68, s71
    v_dot2_f32_bf16 v126, v130, v102, v126
    v_dot2_f32_bf16 v127, v131, v102, v127
    v_perm_b32 v132, v79, v69, s70
    v_perm_b32 v133, v79, v69, s71
    v_dot2_f32_bf16 v128, v132, v102, v128
    v_dot2_f32_bf16 v129, v133, v102, v129
    v_perm_b32 v130, v90, v80, s70
    v_perm_b32 v131, v90, v80, s71
    v_dot2_f32_bf16 v110, v130, v103, v110
    v_dot2_f32_bf16 v111, v131, v103, v111
    v_perm_b32 v132, v91, v81, s70
    v_perm_b32 v133, v91, v81, s71
    v_dot2_f32_bf16 v112, v132, v103, v112
    v_dot2_f32_bf16 v113, v133, v103, v113
    v_perm_b32 v134, v92, v82, s70
    v_perm_b32 v135, v92, v82, s71
    v_dot2_f32_bf16 v114, v134, v103, v114
    v_dot2_f32_bf16 v115, v135, v103, v115
    v_perm_b32 v136, v93, v83, s70
    v_perm_b32 v137, v93, v83, s71
    v_dot2_f32_bf16 v116, v136, v103, v116
    v_dot2_f32_bf16 v117, v137, v103, v117
    v_perm_b32 v130, v94, v84, s70
    v_perm_b32 v131, v94, v84, s71
    v_dot2_f32_bf16 v118, v130, v103, v118
    v_dot2_f32_bf16 v119, v131, v103, v119
    v_perm_b32 v132, v95, v85, s70
    v_perm_b32 v133, v95, v85, s71
    v_dot2_f32_bf16 v120, v132, v103, v120
    v_dot2_f32_bf16 v121, v133, v103, v121
    v_perm_b32 v134, v96, v86, s70
    v_perm_b32 v135, v96, v86, s71
    v_dot2_f32_bf16 v122, v134, v103, v122
    v_dot2_f32_bf16 v123, v135, v103, v123
    v_perm_b32 v136, v97, v87, s70
    v_perm_b32 v137, v97, v87, s71
    v_dot2_f32_bf16 v124, v136, v103, v124
    v_dot2_f32_bf16 v125, v137, v103, v125
    v_perm_b32 v130, v98, v88, s70
    v_perm_b32 v131, v98, v88, s71
    v_dot2_f32_bf16 v126, v130, v103, v126
    v_dot2_f32_bf16 v127, v131, v103, v127
    v_perm_b32 v132, v99, v89, s70
    v_perm_b32 v133, v99, v89, s71
    v_dot2_f32_bf16 v128, v132, v103, v128
    v_dot2_f32_bf16 v129, v133, v103, v129
    s_nop 3
    v_cvt_pk_bf16_f32 v8, v110, v111
    v_cvt_pk_bf16_f32 v9, v112, v113
    v_cvt_pk_bf16_f32 v10, v114, v115
    v_cvt_pk_bf16_f32 v11, v116, v117
    v_cvt_pk_bf16_f32 v12, v118, v119
    v_cvt_pk_bf16_f32 v13, v120, v121
    v_cvt_pk_bf16_f32 v14, v122, v123
    v_cvt_pk_bf16_f32 v15, v124, v125
    v_cvt_pk_bf16_f32 v16, v126, v127
    v_cvt_pk_bf16_f32 v17, v128, v129
    v_lshrrev_b32 v5, 4, v6
    v_mul_u32_u24 v5, 69632, v5
    v_and_b32 v7, 15, v6
    v_lshl_add_u32 v5, v7, 4, v5
    s_lshl_b32 s52, s4, 2
    s_add_u32 s52, s52, s53
    s_mul_i32 s52, s52, 5
    s_lshr_b32 s55, s52, 1
    s_lshl_b32 s55, s55, 8
    s_and_b32 s54, s52, 1
    s_cmp_lg_u32 s54, 0
    s_cbranch_scc1 qkv_odd
    buffer_store_dwordx4 v[8:11], v5, s[44:47], s55 offen
    buffer_store_dwordx4 v[12:15], v5, s[44:47], s55 offen offset:256
    buffer_store_dwordx2 v[16:17], v5, s[44:47], s55 offen offset:512
    s_branch qkv_stored
qkv_odd:
    buffer_store_dwordx2 v[8:9], v5, s[44:47], s55 offen offset:8
    buffer_store_dwordx4 v[10:13], v5, s[44:47], s55 offen offset:256
    buffer_store_dwordx4 v[14:17], v5, s[44:47], s55 offen offset:512
qkv_stored:
k1_done:
    s_endpgm
.section .rodata,"a"
.p2align 6
.amdhsa_kernel gemm1_kernel
  .amdhsa_next_free_vgpr 256
  .amdhsa_next_free_sgpr 98
  .amdhsa_accum_offset 256
  .amdhsa_group_segment_fixed_size 0
  .amdhsa_kernarg_size 80
  .amdhsa_user_sgpr_count 2
  .amdhsa_user_sgpr_kernarg_segment_ptr 1
  .amdhsa_system_sgpr_workgroup_id_x 1
.end_amdhsa_kernel
.text
.globl gemm2_kernel
.p2align 8
.type gemm2_kernel,@function
gemm2_kernel:
    s_cmp_ge_u32 s2, 256
    s_cbranch_scc1 k2_done
    s_load_dwordx16 s[16:31], s[0:1], 0
    s_load_dwordx4 s[32:35], s[0:1], 64
    s_and_b32 s56, s2, 7
    s_lshr_b32 s57, s2, 3
    s_lshr_b32 s4, s56, 1
    s_lshl_b32 s4, s4, 3
    s_lshr_b32 s58, s57, 2
    s_add_u32 s4, s4, s58
    s_and_b32 s5, s56, 1
    s_lshl_b32 s5, s5, 2
    s_and_b32 s58, s57, 3
    s_add_u32 s5, s5, s58
    s_lshl_b32 s6, s4, 6
    s_mul_i32 s7, s5, 160
    v_lshrrev_b32 v1, 6, v0
    v_and_b32 v2, 63, v0
    v_readfirstlane_b32 s8, v1
    v_and_b32 v3, 15, v2
    v_lshrrev_b32 v4, 4, v2
    v_lshlrev_b32 v5, 4, v2
    s_mul_i32 s56, s4, 278528
    v_add_u32 v228, s56, v5
    v_add_u32 v229, 69632, v228
    v_add_u32 v230, 139264, v228
    v_add_u32 v231, 208896, v228
    s_mul_i32 s56, s5, 348160
    v_add_u32 v232, s56, v5
    v_add_u32 v233, 4096, v232
    s_lshl_b32 s12, s8, 10
    s_mul_i32 s13, s8, 5120
    s_waitcnt lgkmcnt(0)
    s_mov_b32 s40, s34
    s_and_b32 s41, s35, 0xffff
    s_mov_b32 s42, 8912896
    s_mov_b32 s43, 0x20000
    s_add_u32 s44, s34, 8912896
    s_addc_u32 s45, s35, 0
    s_and_b32 s45, s45, 0xffff
    s_mov_b32 s46, 2785280
    s_mov_b32 s47, 0x20000
    buffer_load_dwordx4 v[8:11], v228, s[40:43], s12 offen
    buffer_load_dwordx4 v[12:15], v229, s[40:43], s12 offen
    buffer_load_dwordx4 v[16:19], v230, s[40:43], s12 offen
    buffer_load_dwordx4 v[20:23], v231, s[40:43], s12 offen
    buffer_load_dwordx4 v[24:27], v232, s[44:47], s13 offen offset:0
    buffer_load_dwordx4 v[28:31], v232, s[44:47], s13 offen offset:1024
    buffer_load_dwordx4 v[32:35], v232, s[44:47], s13 offen offset:2048
    buffer_load_dwordx4 v[36:39], v232, s[44:47], s13 offen offset:3072
    buffer_load_dwordx4 v[40:43], v233, s[44:47], s13 offen
    s_add_u32 s12, s12, 4096
    s_add_u32 s13, s13, 20480
    buffer_load_dwordx4 v[44:47], v228, s[40:43], s12 offen
    buffer_load_dwordx4 v[48:51], v229, s[40:43], s12 offen
    buffer_load_dwordx4 v[52:55], v230, s[40:43], s12 offen
    buffer_load_dwordx4 v[56:59], v231, s[40:43], s12 offen
    buffer_load_dwordx4 v[60:63], v232, s[44:47], s13 offen offset:0
    buffer_load_dwordx4 v[64:67], v232, s[44:47], s13 offen offset:1024
    buffer_load_dwordx4 v[68:71], v232, s[44:47], s13 offen offset:2048
    buffer_load_dwordx4 v[72:75], v232, s[44:47], s13 offen offset:3072
    buffer_load_dwordx4 v[76:79], v233, s[44:47], s13 offen
    s_add_u32 s12, s12, 4096
    s_add_u32 s13, s13, 20480
    buffer_load_dwordx4 v[80:83], v228, s[40:43], s12 offen
    buffer_load_dwordx4 v[84:87], v229, s[40:43], s12 offen
    buffer_load_dwordx4 v[88:91], v230, s[40:43], s12 offen
    buffer_load_dwordx4 v[92:95], v231, s[40:43], s12 offen
    buffer_load_dwordx4 v[96:99], v232, s[44:47], s13 offen offset:0
    buffer_load_dwordx4 v[100:103], v232, s[44:47], s13 offen offset:1024
    buffer_load_dwordx4 v[104:107], v232, s[44:47], s13 offen offset:2048
    buffer_load_dwordx4 v[108:111], v232, s[44:47], s13 offen offset:3072
    buffer_load_dwordx4 v[112:115], v233, s[44:47], s13 offen
    s_add_u32 s12, s12, 4096
    s_add_u32 s13, s13, 20480
    s_mov_b32 s48, s16
    s_and_b32 s49, s17, 0xffff
    s_mov_b32 s50, 2621440
    s_mov_b32 s51, 0x20000
    s_mov_b32 s52, s30
    s_and_b32 s53, s31, 0xffff
    s_mov_b32 s54, 2621440
    s_mov_b32 s55, 0x20000
    s_lshl_b32 s56, s8, 4
    s_add_u32 s58, s56, s6
    v_add_u32 v5, 0, v2
    v_mul_u32_u24 v6, 205, v5
    v_lshrrev_b32 v6, 11, v6
    v_mul_u32_u24 v7, 10, v6
    v_sub_u32 v7, v5, v7
    v_add_u32 v1, s58, v6
    v_mul_u32_u24 v1, 1280, v1
    v_lshl_add_u32 v1, v7, 4, v1
    v_add_u32 v248, s7, v1
    v_add_u32 v1, s56, v6
    v_mul_u32_u24 v1, 336, v1
    v_lshl_add_u32 v251, v7, 5, v1
    v_add_u32 v5, 64, v2
    v_mul_u32_u24 v6, 205, v5
    v_lshrrev_b32 v6, 11, v6
    v_mul_u32_u24 v7, 10, v6
    v_sub_u32 v7, v5, v7
    v_add_u32 v1, s58, v6
    v_mul_u32_u24 v1, 1280, v1
    v_lshl_add_u32 v1, v7, 4, v1
    v_add_u32 v249, s7, v1
    v_add_u32 v1, s56, v6
    v_mul_u32_u24 v1, 336, v1
    v_lshl_add_u32 v252, v7, 5, v1
    v_add_u32 v5, 128, v2
    v_mul_u32_u24 v6, 205, v5
    v_lshrrev_b32 v6, 11, v6
    v_mul_u32_u24 v7, 10, v6
    v_sub_u32 v7, v5, v7
    v_add_u32 v1, s58, v6
    v_mul_u32_u24 v1, 1280, v1
    v_lshl_add_u32 v1, v7, 4, v1
    v_add_u32 v250, s7, v1
    v_add_u32 v1, s56, v6
    v_mul_u32_u24 v1, 336, v1
    v_lshl_add_u32 v253, v7, 5, v1
    v_cmp_gt_u32 vcc, 32, v2
    v_mov_b32 v1, 0x7f000000
    s_nop 1
    v_cndmask_b32 v250, v1, v250, vcc
    v_cndmask_b32 v253, 0, v253, vcc
    buffer_load_dwordx4 v[236:239], v248, s[48:51], 0 offen
    buffer_load_dwordx4 v[240:243], v249, s[48:51], 0 offen
    buffer_load_dwordx4 v[244:247], v250, s[48:51], 0 offen
    v_accvgpr_write_b32 a0, 0
    v_accvgpr_write_b32 a1, 0
    v_accvgpr_write_b32 a2, 0
    v_accvgpr_write_b32 a3, 0
    v_accvgpr_write_b32 a4, 0
    v_accvgpr_write_b32 a5, 0
    v_accvgpr_write_b32 a6, 0
    v_accvgpr_write_b32 a7, 0
    v_accvgpr_write_b32 a8, 0
    v_accvgpr_write_b32 a9, 0
    v_accvgpr_write_b32 a10, 0
    v_accvgpr_write_b32 a11, 0
    v_accvgpr_write_b32 a12, 0
    v_accvgpr_write_b32 a13, 0
    v_accvgpr_write_b32 a14, 0
    v_accvgpr_write_b32 a15, 0
    v_accvgpr_write_b32 a16, 0
    v_accvgpr_write_b32 a17, 0
    v_accvgpr_write_b32 a18, 0
    v_accvgpr_write_b32 a19, 0
    v_accvgpr_write_b32 a20, 0
    v_accvgpr_write_b32 a21, 0
    v_accvgpr_write_b32 a22, 0
    v_accvgpr_write_b32 a23, 0
    v_accvgpr_write_b32 a24, 0
    v_accvgpr_write_b32 a25, 0
    v_accvgpr_write_b32 a26, 0
    v_accvgpr_write_b32 a27, 0
    v_accvgpr_write_b32 a28, 0
    v_accvgpr_write_b32 a29, 0
    v_accvgpr_write_b32 a30, 0
    v_accvgpr_write_b32 a31, 0
    v_accvgpr_write_b32 a32, 0
    v_accvgpr_write_b32 a33, 0
    v_accvgpr_write_b32 a34, 0
    v_accvgpr_write_b32 a35, 0
    v_accvgpr_write_b32 a36, 0
    v_accvgpr_write_b32 a37, 0
    v_accvgpr_write_b32 a38, 0
    v_accvgpr_write_b32 a39, 0
    v_accvgpr_write_b32 a40, 0
    v_accvgpr_write_b32 a41, 0
    v_accvgpr_write_b32 a42, 0
    v_accvgpr_write_b32 a43, 0
    v_accvgpr_write_b32 a44, 0
    v_accvgpr_write_b32 a45, 0
    v_accvgpr_write_b32 a46, 0
    v_accvgpr_write_b32 a47, 0
    v_accvgpr_write_b32 a48, 0
    v_accvgpr_write_b32 a49, 0
    v_accvgpr_write_b32 a50, 0
    v_accvgpr_write_b32 a51, 0
    v_accvgpr_write_b32 a52, 0
    v_accvgpr_write_b32 a53, 0
    v_accvgpr_write_b32 a54, 0
    v_accvgpr_write_b32 a55, 0
    v_accvgpr_write_b32 a56, 0
    v_accvgpr_write_b32 a57, 0
    v_accvgpr_write_b32 a58, 0
    v_accvgpr_write_b32 a59, 0
    v_accvgpr_write_b32 a60, 0
    v_accvgpr_write_b32 a61, 0
    v_accvgpr_write_b32 a62, 0
    v_accvgpr_write_b32 a63, 0
    v_accvgpr_write_b32 a64, 0
    v_accvgpr_write_b32 a65, 0
    v_accvgpr_write_b32 a66, 0
    v_accvgpr_write_b32 a67, 0
    v_accvgpr_write_b32 a68, 0
    v_accvgpr_write_b32 a69, 0
    v_accvgpr_write_b32 a70, 0
    v_accvgpr_write_b32 a71, 0
    v_accvgpr_write_b32 a72, 0
    v_accvgpr_write_b32 a73, 0
    v_accvgpr_write_b32 a74, 0
    v_accvgpr_write_b32 a75, 0
    v_accvgpr_write_b32 a76, 0
    v_accvgpr_write_b32 a77, 0
    v_accvgpr_write_b32 a78, 0
    v_accvgpr_write_b32 a79, 0
    s_waitcnt vmcnt(21)
    v_mfma_f32_16x16x32_bf16 a[0:3], v[24:27], v[8:11], a[0:3]
    v_mfma_f32_16x16x32_bf16 a[20:23], v[24:27], v[12:15], a[20:23]
    buffer_load_dwordx4 v[116:119], v228, s[40:43], s12 offen
    v_mfma_f32_16x16x32_bf16 a[40:43], v[24:27], v[16:19], a[40:43]
    v_mfma_f32_16x16x32_bf16 a[60:63], v[24:27], v[20:23], a[60:63]
    buffer_load_dwordx4 v[120:123], v229, s[40:43], s12 offen
    v_mfma_f32_16x16x32_bf16 a[4:7], v[28:31], v[8:11], a[4:7]
    v_mfma_f32_16x16x32_bf16 a[24:27], v[28:31], v[12:15], a[24:27]
    buffer_load_dwordx4 v[124:127], v230, s[40:43], s12 offen
    v_mfma_f32_16x16x32_bf16 a[44:47], v[28:31], v[16:19], a[44:47]
    v_mfma_f32_16x16x32_bf16 a[64:67], v[28:31], v[20:23], a[64:67]
    buffer_load_dwordx4 v[128:131], v231, s[40:43], s12 offen
    v_mfma_f32_16x16x32_bf16 a[8:11], v[32:35], v[8:11], a[8:11]
    v_mfma_f32_16x16x32_bf16 a[28:31], v[32:35], v[12:15], a[28:31]
    buffer_load_dwordx4 v[132:135], v232, s[44:47], s13 offen offset:0
    v_mfma_f32_16x16x32_bf16 a[48:51], v[32:35], v[16:19], a[48:51]
    v_mfma_f32_16x16x32_bf16 a[68:71], v[32:35], v[20:23], a[68:71]
    buffer_load_dwordx4 v[136:139], v232, s[44:47], s13 offen offset:1024
    v_mfma_f32_16x16x32_bf16 a[12:15], v[36:39], v[8:11], a[12:15]
    v_mfma_f32_16x16x32_bf16 a[32:35], v[36:39], v[12:15], a[32:35]
    buffer_load_dwordx4 v[140:143], v232, s[44:47], s13 offen offset:2048
    v_mfma_f32_16x16x32_bf16 a[52:55], v[36:39], v[16:19], a[52:55]
    v_mfma_f32_16x16x32_bf16 a[72:75], v[36:39], v[20:23], a[72:75]
    buffer_load_dwordx4 v[144:147], v232, s[44:47], s13 offen offset:3072
    v_mfma_f32_16x16x32_bf16 a[16:19], v[40:43], v[8:11], a[16:19]
    v_mfma_f32_16x16x32_bf16 a[36:39], v[40:43], v[12:15], a[36:39]
    buffer_load_dwordx4 v[148:151], v233, s[44:47], s13 offen
    v_mfma_f32_16x16x32_bf16 a[56:59], v[40:43], v[16:19], a[56:59]
    v_mfma_f32_16x16x32_bf16 a[76:79], v[40:43], v[20:23], a[76:79]
    s_add_u32 s12, s12, 4096
    s_add_u32 s13, s13, 20480
    s_waitcnt vmcnt(21)
    v_mfma_f32_16x16x32_bf16 a[0:3], v[60:63], v[44:47], a[0:3]
    v_mfma_f32_16x16x32_bf16 a[20:23], v[60:63], v[48:51], a[20:23]
    buffer_load_dwordx4 v[8:11], v228, s[40:43], s12 offen
    v_mfma_f32_16x16x32_bf16 a[40:43], v[60:63], v[52:55], a[40:43]
    v_mfma_f32_16x16x32_bf16 a[60:63], v[60:63], v[56:59], a[60:63]
    buffer_load_dwordx4 v[12:15], v229, s[40:43], s12 offen
    v_mfma_f32_16x16x32_bf16 a[4:7], v[64:67], v[44:47], a[4:7]
    v_mfma_f32_16x16x32_bf16 a[24:27], v[64:67], v[48:51], a[24:27]
    buffer_load_dwordx4 v[16:19], v230, s[40:43], s12 offen
    v_mfma_f32_16x16x32_bf16 a[44:47], v[64:67], v[52:55], a[44:47]
    v_mfma_f32_16x16x32_bf16 a[64:67], v[64:67], v[56:59], a[64:67]
    buffer_load_dwordx4 v[20:23], v231, s[40:43], s12 offen
    v_mfma_f32_16x16x32_bf16 a[8:11], v[68:71], v[44:47], a[8:11]
    v_mfma_f32_16x16x32_bf16 a[28:31], v[68:71], v[48:51], a[28:31]
    buffer_load_dwordx4 v[24:27], v232, s[44:47], s13 offen offset:0
    v_mfma_f32_16x16x32_bf16 a[48:51], v[68:71], v[52:55], a[48:51]
    v_mfma_f32_16x16x32_bf16 a[68:71], v[68:71], v[56:59], a[68:71]
    buffer_load_dwordx4 v[28:31], v232, s[44:47], s13 offen offset:1024
    v_mfma_f32_16x16x32_bf16 a[12:15], v[72:75], v[44:47], a[12:15]
    v_mfma_f32_16x16x32_bf16 a[32:35], v[72:75], v[48:51], a[32:35]
    buffer_load_dwordx4 v[32:35], v232, s[44:47], s13 offen offset:2048
    v_mfma_f32_16x16x32_bf16 a[52:55], v[72:75], v[52:55], a[52:55]
    v_mfma_f32_16x16x32_bf16 a[72:75], v[72:75], v[56:59], a[72:75]
    buffer_load_dwordx4 v[36:39], v232, s[44:47], s13 offen offset:3072
    v_mfma_f32_16x16x32_bf16 a[16:19], v[76:79], v[44:47], a[16:19]
    v_mfma_f32_16x16x32_bf16 a[36:39], v[76:79], v[48:51], a[36:39]
    buffer_load_dwordx4 v[40:43], v233, s[44:47], s13 offen
    v_mfma_f32_16x16x32_bf16 a[56:59], v[76:79], v[52:55], a[56:59]
    v_mfma_f32_16x16x32_bf16 a[76:79], v[76:79], v[56:59], a[76:79]
    s_add_u32 s12, s12, 4096
    s_add_u32 s13, s13, 20480
    s_waitcnt vmcnt(21)
    v_mfma_f32_16x16x32_bf16 a[0:3], v[96:99], v[80:83], a[0:3]
    v_mfma_f32_16x16x32_bf16 a[20:23], v[96:99], v[84:87], a[20:23]
    buffer_load_dwordx4 v[44:47], v228, s[40:43], s12 offen
    v_mfma_f32_16x16x32_bf16 a[40:43], v[96:99], v[88:91], a[40:43]
    v_mfma_f32_16x16x32_bf16 a[60:63], v[96:99], v[92:95], a[60:63]
    buffer_load_dwordx4 v[48:51], v229, s[40:43], s12 offen
    v_mfma_f32_16x16x32_bf16 a[4:7], v[100:103], v[80:83], a[4:7]
    v_mfma_f32_16x16x32_bf16 a[24:27], v[100:103], v[84:87], a[24:27]
    buffer_load_dwordx4 v[52:55], v230, s[40:43], s12 offen
    v_mfma_f32_16x16x32_bf16 a[44:47], v[100:103], v[88:91], a[44:47]
    v_mfma_f32_16x16x32_bf16 a[64:67], v[100:103], v[92:95], a[64:67]
    buffer_load_dwordx4 v[56:59], v231, s[40:43], s12 offen
    v_mfma_f32_16x16x32_bf16 a[8:11], v[104:107], v[80:83], a[8:11]
    v_mfma_f32_16x16x32_bf16 a[28:31], v[104:107], v[84:87], a[28:31]
    buffer_load_dwordx4 v[60:63], v232, s[44:47], s13 offen offset:0
    v_mfma_f32_16x16x32_bf16 a[48:51], v[104:107], v[88:91], a[48:51]
    v_mfma_f32_16x16x32_bf16 a[68:71], v[104:107], v[92:95], a[68:71]
    buffer_load_dwordx4 v[64:67], v232, s[44:47], s13 offen offset:1024
    v_mfma_f32_16x16x32_bf16 a[12:15], v[108:111], v[80:83], a[12:15]
    v_mfma_f32_16x16x32_bf16 a[32:35], v[108:111], v[84:87], a[32:35]
    buffer_load_dwordx4 v[68:71], v232, s[44:47], s13 offen offset:2048
    v_mfma_f32_16x16x32_bf16 a[52:55], v[108:111], v[88:91], a[52:55]
    v_mfma_f32_16x16x32_bf16 a[72:75], v[108:111], v[92:95], a[72:75]
    buffer_load_dwordx4 v[72:75], v232, s[44:47], s13 offen offset:3072
    v_mfma_f32_16x16x32_bf16 a[16:19], v[112:115], v[80:83], a[16:19]
    v_mfma_f32_16x16x32_bf16 a[36:39], v[112:115], v[84:87], a[36:39]
    buffer_load_dwordx4 v[76:79], v233, s[44:47], s13 offen
    v_mfma_f32_16x16x32_bf16 a[56:59], v[112:115], v[88:91], a[56:59]
    v_mfma_f32_16x16x32_bf16 a[76:79], v[112:115], v[92:95], a[76:79]
    s_add_u32 s12, s12, 4096
    s_add_u32 s13, s13, 20480
    s_waitcnt vmcnt(18)
    v_mfma_f32_16x16x32_bf16 a[0:3], v[132:135], v[116:119], a[0:3]
    v_mfma_f32_16x16x32_bf16 a[20:23], v[132:135], v[120:123], a[20:23]
    buffer_load_dwordx4 v[80:83], v228, s[40:43], s12 offen
    v_mfma_f32_16x16x32_bf16 a[40:43], v[132:135], v[124:127], a[40:43]
    v_mfma_f32_16x16x32_bf16 a[60:63], v[132:135], v[128:131], a[60:63]
    buffer_load_dwordx4 v[84:87], v229, s[40:43], s12 offen
    v_mfma_f32_16x16x32_bf16 a[4:7], v[136:139], v[116:119], a[4:7]
    v_mfma_f32_16x16x32_bf16 a[24:27], v[136:139], v[120:123], a[24:27]
    buffer_load_dwordx4 v[88:91], v230, s[40:43], s12 offen
    v_mfma_f32_16x16x32_bf16 a[44:47], v[136:139], v[124:127], a[44:47]
    v_mfma_f32_16x16x32_bf16 a[64:67], v[136:139], v[128:131], a[64:67]
    buffer_load_dwordx4 v[92:95], v231, s[40:43], s12 offen
    v_mfma_f32_16x16x32_bf16 a[8:11], v[140:143], v[116:119], a[8:11]
    v_mfma_f32_16x16x32_bf16 a[28:31], v[140:143], v[120:123], a[28:31]
    buffer_load_dwordx4 v[96:99], v232, s[44:47], s13 offen offset:0
    v_mfma_f32_16x16x32_bf16 a[48:51], v[140:143], v[124:127], a[48:51]
    v_mfma_f32_16x16x32_bf16 a[68:71], v[140:143], v[128:131], a[68:71]
    buffer_load_dwordx4 v[100:103], v232, s[44:47], s13 offen offset:1024
    v_mfma_f32_16x16x32_bf16 a[12:15], v[144:147], v[116:119], a[12:15]
    v_mfma_f32_16x16x32_bf16 a[32:35], v[144:147], v[120:123], a[32:35]
    buffer_load_dwordx4 v[104:107], v232, s[44:47], s13 offen offset:2048
    v_mfma_f32_16x16x32_bf16 a[52:55], v[144:147], v[124:127], a[52:55]
    v_mfma_f32_16x16x32_bf16 a[72:75], v[144:147], v[128:131], a[72:75]
    buffer_load_dwordx4 v[108:111], v232, s[44:47], s13 offen offset:3072
    v_mfma_f32_16x16x32_bf16 a[16:19], v[148:151], v[116:119], a[16:19]
    v_mfma_f32_16x16x32_bf16 a[36:39], v[148:151], v[120:123], a[36:39]
    buffer_load_dwordx4 v[112:115], v233, s[44:47], s13 offen
    v_mfma_f32_16x16x32_bf16 a[56:59], v[148:151], v[124:127], a[56:59]
    v_mfma_f32_16x16x32_bf16 a[76:79], v[148:151], v[128:131], a[76:79]
    s_add_u32 s12, s12, 4096
    s_add_u32 s13, s13, 20480
    s_waitcnt vmcnt(18)
    v_mfma_f32_16x16x32_bf16 a[0:3], v[24:27], v[8:11], a[0:3]
    v_mfma_f32_16x16x32_bf16 a[20:23], v[24:27], v[12:15], a[20:23]
    buffer_load_dwordx4 v[116:119], v228, s[40:43], s12 offen
    v_mfma_f32_16x16x32_bf16 a[40:43], v[24:27], v[16:19], a[40:43]
    v_mfma_f32_16x16x32_bf16 a[60:63], v[24:27], v[20:23], a[60:63]
    buffer_load_dwordx4 v[120:123], v229, s[40:43], s12 offen
    v_mfma_f32_16x16x32_bf16 a[4:7], v[28:31], v[8:11], a[4:7]
    v_mfma_f32_16x16x32_bf16 a[24:27], v[28:31], v[12:15], a[24:27]
    buffer_load_dwordx4 v[124:127], v230, s[40:43], s12 offen
    v_mfma_f32_16x16x32_bf16 a[44:47], v[28:31], v[16:19], a[44:47]
    v_mfma_f32_16x16x32_bf16 a[64:67], v[28:31], v[20:23], a[64:67]
    buffer_load_dwordx4 v[128:131], v231, s[40:43], s12 offen
    v_mfma_f32_16x16x32_bf16 a[8:11], v[32:35], v[8:11], a[8:11]
    v_mfma_f32_16x16x32_bf16 a[28:31], v[32:35], v[12:15], a[28:31]
    buffer_load_dwordx4 v[132:135], v232, s[44:47], s13 offen offset:0
    v_mfma_f32_16x16x32_bf16 a[48:51], v[32:35], v[16:19], a[48:51]
    v_mfma_f32_16x16x32_bf16 a[68:71], v[32:35], v[20:23], a[68:71]
    buffer_load_dwordx4 v[136:139], v232, s[44:47], s13 offen offset:1024
    v_mfma_f32_16x16x32_bf16 a[12:15], v[36:39], v[8:11], a[12:15]
    v_mfma_f32_16x16x32_bf16 a[32:35], v[36:39], v[12:15], a[32:35]
    buffer_load_dwordx4 v[140:143], v232, s[44:47], s13 offen offset:2048
    v_mfma_f32_16x16x32_bf16 a[52:55], v[36:39], v[16:19], a[52:55]
    v_mfma_f32_16x16x32_bf16 a[72:75], v[36:39], v[20:23], a[72:75]
    buffer_load_dwordx4 v[144:147], v232, s[44:47], s13 offen offset:3072
    v_mfma_f32_16x16x32_bf16 a[16:19], v[40:43], v[8:11], a[16:19]
    v_mfma_f32_16x16x32_bf16 a[36:39], v[40:43], v[12:15], a[36:39]
    buffer_load_dwordx4 v[148:151], v233, s[44:47], s13 offen
    v_mfma_f32_16x16x32_bf16 a[56:59], v[40:43], v[16:19], a[56:59]
    v_mfma_f32_16x16x32_bf16 a[76:79], v[40:43], v[20:23], a[76:79]
    s_add_u32 s12, s12, 4096
    s_add_u32 s13, s13, 20480
    s_waitcnt vmcnt(18)
    v_mfma_f32_16x16x32_bf16 a[0:3], v[60:63], v[44:47], a[0:3]
    v_mfma_f32_16x16x32_bf16 a[20:23], v[60:63], v[48:51], a[20:23]
    buffer_load_dwordx4 v[8:11], v228, s[40:43], s12 offen
    v_mfma_f32_16x16x32_bf16 a[40:43], v[60:63], v[52:55], a[40:43]
    v_mfma_f32_16x16x32_bf16 a[60:63], v[60:63], v[56:59], a[60:63]
    buffer_load_dwordx4 v[12:15], v229, s[40:43], s12 offen
    v_mfma_f32_16x16x32_bf16 a[4:7], v[64:67], v[44:47], a[4:7]
    v_mfma_f32_16x16x32_bf16 a[24:27], v[64:67], v[48:51], a[24:27]
    buffer_load_dwordx4 v[16:19], v230, s[40:43], s12 offen
    v_mfma_f32_16x16x32_bf16 a[44:47], v[64:67], v[52:55], a[44:47]
    v_mfma_f32_16x16x32_bf16 a[64:67], v[64:67], v[56:59], a[64:67]
    buffer_load_dwordx4 v[20:23], v231, s[40:43], s12 offen
    v_mfma_f32_16x16x32_bf16 a[8:11], v[68:71], v[44:47], a[8:11]
    v_mfma_f32_16x16x32_bf16 a[28:31], v[68:71], v[48:51], a[28:31]
    buffer_load_dwordx4 v[24:27], v232, s[44:47], s13 offen offset:0
    v_mfma_f32_16x16x32_bf16 a[48:51], v[68:71], v[52:55], a[48:51]
    v_mfma_f32_16x16x32_bf16 a[68:71], v[68:71], v[56:59], a[68:71]
    buffer_load_dwordx4 v[28:31], v232, s[44:47], s13 offen offset:1024
    v_mfma_f32_16x16x32_bf16 a[12:15], v[72:75], v[44:47], a[12:15]
    v_mfma_f32_16x16x32_bf16 a[32:35], v[72:75], v[48:51], a[32:35]
    buffer_load_dwordx4 v[32:35], v232, s[44:47], s13 offen offset:2048
    v_mfma_f32_16x16x32_bf16 a[52:55], v[72:75], v[52:55], a[52:55]
    v_mfma_f32_16x16x32_bf16 a[72:75], v[72:75], v[56:59], a[72:75]
    buffer_load_dwordx4 v[36:39], v232, s[44:47], s13 offen offset:3072
    v_mfma_f32_16x16x32_bf16 a[16:19], v[76:79], v[44:47], a[16:19]
    v_mfma_f32_16x16x32_bf16 a[36:39], v[76:79], v[48:51], a[36:39]
    buffer_load_dwordx4 v[40:43], v233, s[44:47], s13 offen
    v_mfma_f32_16x16x32_bf16 a[56:59], v[76:79], v[52:55], a[56:59]
    v_mfma_f32_16x16x32_bf16 a[76:79], v[76:79], v[56:59], a[76:79]
    s_add_u32 s12, s12, 4096
    s_add_u32 s13, s13, 20480
    s_waitcnt vmcnt(18)
    v_mfma_f32_16x16x32_bf16 a[0:3], v[96:99], v[80:83], a[0:3]
    v_mfma_f32_16x16x32_bf16 a[20:23], v[96:99], v[84:87], a[20:23]
    buffer_load_dwordx4 v[44:47], v228, s[40:43], s12 offen
    v_mfma_f32_16x16x32_bf16 a[40:43], v[96:99], v[88:91], a[40:43]
    v_mfma_f32_16x16x32_bf16 a[60:63], v[96:99], v[92:95], a[60:63]
    buffer_load_dwordx4 v[48:51], v229, s[40:43], s12 offen
    v_mfma_f32_16x16x32_bf16 a[4:7], v[100:103], v[80:83], a[4:7]
    v_mfma_f32_16x16x32_bf16 a[24:27], v[100:103], v[84:87], a[24:27]
    buffer_load_dwordx4 v[52:55], v230, s[40:43], s12 offen
    v_mfma_f32_16x16x32_bf16 a[44:47], v[100:103], v[88:91], a[44:47]
    v_mfma_f32_16x16x32_bf16 a[64:67], v[100:103], v[92:95], a[64:67]
    buffer_load_dwordx4 v[56:59], v231, s[40:43], s12 offen
    v_mfma_f32_16x16x32_bf16 a[8:11], v[104:107], v[80:83], a[8:11]
    v_mfma_f32_16x16x32_bf16 a[28:31], v[104:107], v[84:87], a[28:31]
    buffer_load_dwordx4 v[60:63], v232, s[44:47], s13 offen offset:0
    v_mfma_f32_16x16x32_bf16 a[48:51], v[104:107], v[88:91], a[48:51]
    v_mfma_f32_16x16x32_bf16 a[68:71], v[104:107], v[92:95], a[68:71]
    buffer_load_dwordx4 v[64:67], v232, s[44:47], s13 offen offset:1024
    v_mfma_f32_16x16x32_bf16 a[12:15], v[108:111], v[80:83], a[12:15]
    v_mfma_f32_16x16x32_bf16 a[32:35], v[108:111], v[84:87], a[32:35]
    buffer_load_dwordx4 v[68:71], v232, s[44:47], s13 offen offset:2048
    v_mfma_f32_16x16x32_bf16 a[52:55], v[108:111], v[88:91], a[52:55]
    v_mfma_f32_16x16x32_bf16 a[72:75], v[108:111], v[92:95], a[72:75]
    buffer_load_dwordx4 v[72:75], v232, s[44:47], s13 offen offset:3072
    v_mfma_f32_16x16x32_bf16 a[16:19], v[112:115], v[80:83], a[16:19]
    v_mfma_f32_16x16x32_bf16 a[36:39], v[112:115], v[84:87], a[36:39]
    buffer_load_dwordx4 v[76:79], v233, s[44:47], s13 offen
    v_mfma_f32_16x16x32_bf16 a[56:59], v[112:115], v[88:91], a[56:59]
    v_mfma_f32_16x16x32_bf16 a[76:79], v[112:115], v[92:95], a[76:79]
    s_add_u32 s12, s12, 4096
    s_add_u32 s13, s13, 20480
    s_waitcnt vmcnt(18)
    v_mfma_f32_16x16x32_bf16 a[0:3], v[132:135], v[116:119], a[0:3]
    v_mfma_f32_16x16x32_bf16 a[20:23], v[132:135], v[120:123], a[20:23]
    buffer_load_dwordx4 v[80:83], v228, s[40:43], s12 offen
    v_mfma_f32_16x16x32_bf16 a[40:43], v[132:135], v[124:127], a[40:43]
    v_mfma_f32_16x16x32_bf16 a[60:63], v[132:135], v[128:131], a[60:63]
    buffer_load_dwordx4 v[84:87], v229, s[40:43], s12 offen
    v_mfma_f32_16x16x32_bf16 a[4:7], v[136:139], v[116:119], a[4:7]
    v_mfma_f32_16x16x32_bf16 a[24:27], v[136:139], v[120:123], a[24:27]
    buffer_load_dwordx4 v[88:91], v230, s[40:43], s12 offen
    v_mfma_f32_16x16x32_bf16 a[44:47], v[136:139], v[124:127], a[44:47]
    v_mfma_f32_16x16x32_bf16 a[64:67], v[136:139], v[128:131], a[64:67]
    buffer_load_dwordx4 v[92:95], v231, s[40:43], s12 offen
    v_mfma_f32_16x16x32_bf16 a[8:11], v[140:143], v[116:119], a[8:11]
    v_mfma_f32_16x16x32_bf16 a[28:31], v[140:143], v[120:123], a[28:31]
    buffer_load_dwordx4 v[96:99], v232, s[44:47], s13 offen offset:0
    v_mfma_f32_16x16x32_bf16 a[48:51], v[140:143], v[124:127], a[48:51]
    v_mfma_f32_16x16x32_bf16 a[68:71], v[140:143], v[128:131], a[68:71]
    buffer_load_dwordx4 v[100:103], v232, s[44:47], s13 offen offset:1024
    v_mfma_f32_16x16x32_bf16 a[12:15], v[144:147], v[116:119], a[12:15]
    v_mfma_f32_16x16x32_bf16 a[32:35], v[144:147], v[120:123], a[32:35]
    buffer_load_dwordx4 v[104:107], v232, s[44:47], s13 offen offset:2048
    v_mfma_f32_16x16x32_bf16 a[52:55], v[144:147], v[124:127], a[52:55]
    v_mfma_f32_16x16x32_bf16 a[72:75], v[144:147], v[128:131], a[72:75]
    buffer_load_dwordx4 v[108:111], v232, s[44:47], s13 offen offset:3072
    v_mfma_f32_16x16x32_bf16 a[16:19], v[148:151], v[116:119], a[16:19]
    v_mfma_f32_16x16x32_bf16 a[36:39], v[148:151], v[120:123], a[36:39]
    buffer_load_dwordx4 v[112:115], v233, s[44:47], s13 offen
    v_mfma_f32_16x16x32_bf16 a[56:59], v[148:151], v[124:127], a[56:59]
    v_mfma_f32_16x16x32_bf16 a[76:79], v[148:151], v[128:131], a[76:79]
    s_add_u32 s12, s12, 4096
    s_add_u32 s13, s13, 20480
    s_waitcnt vmcnt(18)
    v_mfma_f32_16x16x32_bf16 a[0:3], v[24:27], v[8:11], a[0:3]
    v_mfma_f32_16x16x32_bf16 a[20:23], v[24:27], v[12:15], a[20:23]
    buffer_load_dwordx4 v[116:119], v228, s[40:43], s12 offen
    v_mfma_f32_16x16x32_bf16 a[40:43], v[24:27], v[16:19], a[40:43]
    v_mfma_f32_16x16x32_bf16 a[60:63], v[24:27], v[20:23], a[60:63]
    buffer_load_dwordx4 v[120:123], v229, s[40:43], s12 offen
    v_mfma_f32_16x16x32_bf16 a[4:7], v[28:31], v[8:11], a[4:7]
    v_mfma_f32_16x16x32_bf16 a[24:27], v[28:31], v[12:15], a[24:27]
    buffer_load_dwordx4 v[124:127], v230, s[40:43], s12 offen
    v_mfma_f32_16x16x32_bf16 a[44:47], v[28:31], v[16:19], a[44:47]
    v_mfma_f32_16x16x32_bf16 a[64:67], v[28:31], v[20:23], a[64:67]
    buffer_load_dwordx4 v[128:131], v231, s[40:43], s12 offen
    v_mfma_f32_16x16x32_bf16 a[8:11], v[32:35], v[8:11], a[8:11]
    v_mfma_f32_16x16x32_bf16 a[28:31], v[32:35], v[12:15], a[28:31]
    buffer_load_dwordx4 v[132:135], v232, s[44:47], s13 offen offset:0
    v_mfma_f32_16x16x32_bf16 a[48:51], v[32:35], v[16:19], a[48:51]
    v_mfma_f32_16x16x32_bf16 a[68:71], v[32:35], v[20:23], a[68:71]
    buffer_load_dwordx4 v[136:139], v232, s[44:47], s13 offen offset:1024
    v_mfma_f32_16x16x32_bf16 a[12:15], v[36:39], v[8:11], a[12:15]
    v_mfma_f32_16x16x32_bf16 a[32:35], v[36:39], v[12:15], a[32:35]
    buffer_load_dwordx4 v[140:143], v232, s[44:47], s13 offen offset:2048
    v_mfma_f32_16x16x32_bf16 a[52:55], v[36:39], v[16:19], a[52:55]
    v_mfma_f32_16x16x32_bf16 a[72:75], v[36:39], v[20:23], a[72:75]
    buffer_load_dwordx4 v[144:147], v232, s[44:47], s13 offen offset:3072
    v_mfma_f32_16x16x32_bf16 a[16:19], v[40:43], v[8:11], a[16:19]
    v_mfma_f32_16x16x32_bf16 a[36:39], v[40:43], v[12:15], a[36:39]
    buffer_load_dwordx4 v[148:151], v233, s[44:47], s13 offen
    v_mfma_f32_16x16x32_bf16 a[56:59], v[40:43], v[16:19], a[56:59]
    v_mfma_f32_16x16x32_bf16 a[76:79], v[40:43], v[20:23], a[76:79]
    s_add_u32 s12, s12, 4096
    s_add_u32 s13, s13, 20480
    s_waitcnt vmcnt(18)
    v_mfma_f32_16x16x32_bf16 a[0:3], v[60:63], v[44:47], a[0:3]
    v_mfma_f32_16x16x32_bf16 a[20:23], v[60:63], v[48:51], a[20:23]
    buffer_load_dwordx4 v[8:11], v228, s[40:43], s12 offen
    v_mfma_f32_16x16x32_bf16 a[40:43], v[60:63], v[52:55], a[40:43]
    v_mfma_f32_16x16x32_bf16 a[60:63], v[60:63], v[56:59], a[60:63]
    buffer_load_dwordx4 v[12:15], v229, s[40:43], s12 offen
    v_mfma_f32_16x16x32_bf16 a[4:7], v[64:67], v[44:47], a[4:7]
    v_mfma_f32_16x16x32_bf16 a[24:27], v[64:67], v[48:51], a[24:27]
    buffer_load_dwordx4 v[16:19], v230, s[40:43], s12 offen
    v_mfma_f32_16x16x32_bf16 a[44:47], v[64:67], v[52:55], a[44:47]
    v_mfma_f32_16x16x32_bf16 a[64:67], v[64:67], v[56:59], a[64:67]
    buffer_load_dwordx4 v[20:23], v231, s[40:43], s12 offen
    v_mfma_f32_16x16x32_bf16 a[8:11], v[68:71], v[44:47], a[8:11]
    v_mfma_f32_16x16x32_bf16 a[28:31], v[68:71], v[48:51], a[28:31]
    buffer_load_dwordx4 v[24:27], v232, s[44:47], s13 offen offset:0
    v_mfma_f32_16x16x32_bf16 a[48:51], v[68:71], v[52:55], a[48:51]
    v_mfma_f32_16x16x32_bf16 a[68:71], v[68:71], v[56:59], a[68:71]
    buffer_load_dwordx4 v[28:31], v232, s[44:47], s13 offen offset:1024
    v_mfma_f32_16x16x32_bf16 a[12:15], v[72:75], v[44:47], a[12:15]
    v_mfma_f32_16x16x32_bf16 a[32:35], v[72:75], v[48:51], a[32:35]
    buffer_load_dwordx4 v[32:35], v232, s[44:47], s13 offen offset:2048
    v_mfma_f32_16x16x32_bf16 a[52:55], v[72:75], v[52:55], a[52:55]
    v_mfma_f32_16x16x32_bf16 a[72:75], v[72:75], v[56:59], a[72:75]
    buffer_load_dwordx4 v[36:39], v232, s[44:47], s13 offen offset:3072
    v_mfma_f32_16x16x32_bf16 a[16:19], v[76:79], v[44:47], a[16:19]
    v_mfma_f32_16x16x32_bf16 a[36:39], v[76:79], v[48:51], a[36:39]
    buffer_load_dwordx4 v[40:43], v233, s[44:47], s13 offen
    v_mfma_f32_16x16x32_bf16 a[56:59], v[76:79], v[52:55], a[56:59]
    v_mfma_f32_16x16x32_bf16 a[76:79], v[76:79], v[56:59], a[76:79]
    s_add_u32 s12, s12, 4096
    s_add_u32 s13, s13, 20480
    s_waitcnt vmcnt(18)
    v_mfma_f32_16x16x32_bf16 a[0:3], v[96:99], v[80:83], a[0:3]
    v_mfma_f32_16x16x32_bf16 a[20:23], v[96:99], v[84:87], a[20:23]
    buffer_load_dwordx4 v[44:47], v228, s[40:43], s12 offen
    v_mfma_f32_16x16x32_bf16 a[40:43], v[96:99], v[88:91], a[40:43]
    v_mfma_f32_16x16x32_bf16 a[60:63], v[96:99], v[92:95], a[60:63]
    buffer_load_dwordx4 v[48:51], v229, s[40:43], s12 offen
    v_mfma_f32_16x16x32_bf16 a[4:7], v[100:103], v[80:83], a[4:7]
    v_mfma_f32_16x16x32_bf16 a[24:27], v[100:103], v[84:87], a[24:27]
    buffer_load_dwordx4 v[52:55], v230, s[40:43], s12 offen
    v_mfma_f32_16x16x32_bf16 a[44:47], v[100:103], v[88:91], a[44:47]
    v_mfma_f32_16x16x32_bf16 a[64:67], v[100:103], v[92:95], a[64:67]
    buffer_load_dwordx4 v[56:59], v231, s[40:43], s12 offen
    v_mfma_f32_16x16x32_bf16 a[8:11], v[104:107], v[80:83], a[8:11]
    v_mfma_f32_16x16x32_bf16 a[28:31], v[104:107], v[84:87], a[28:31]
    buffer_load_dwordx4 v[60:63], v232, s[44:47], s13 offen offset:0
    v_mfma_f32_16x16x32_bf16 a[48:51], v[104:107], v[88:91], a[48:51]
    v_mfma_f32_16x16x32_bf16 a[68:71], v[104:107], v[92:95], a[68:71]
    buffer_load_dwordx4 v[64:67], v232, s[44:47], s13 offen offset:1024
    v_mfma_f32_16x16x32_bf16 a[12:15], v[108:111], v[80:83], a[12:15]
    v_mfma_f32_16x16x32_bf16 a[32:35], v[108:111], v[84:87], a[32:35]
    buffer_load_dwordx4 v[68:71], v232, s[44:47], s13 offen offset:2048
    v_mfma_f32_16x16x32_bf16 a[52:55], v[108:111], v[88:91], a[52:55]
    v_mfma_f32_16x16x32_bf16 a[72:75], v[108:111], v[92:95], a[72:75]
    buffer_load_dwordx4 v[72:75], v232, s[44:47], s13 offen offset:3072
    v_mfma_f32_16x16x32_bf16 a[16:19], v[112:115], v[80:83], a[16:19]
    v_mfma_f32_16x16x32_bf16 a[36:39], v[112:115], v[84:87], a[36:39]
    buffer_load_dwordx4 v[76:79], v233, s[44:47], s13 offen
    v_mfma_f32_16x16x32_bf16 a[56:59], v[112:115], v[88:91], a[56:59]
    v_mfma_f32_16x16x32_bf16 a[76:79], v[112:115], v[92:95], a[76:79]
    s_add_u32 s12, s12, 4096
    s_add_u32 s13, s13, 20480
    s_waitcnt vmcnt(18)
    v_mfma_f32_16x16x32_bf16 a[0:3], v[132:135], v[116:119], a[0:3]
    v_mfma_f32_16x16x32_bf16 a[20:23], v[132:135], v[120:123], a[20:23]
    buffer_load_dwordx4 v[80:83], v228, s[40:43], s12 offen
    v_mfma_f32_16x16x32_bf16 a[40:43], v[132:135], v[124:127], a[40:43]
    v_mfma_f32_16x16x32_bf16 a[60:63], v[132:135], v[128:131], a[60:63]
    buffer_load_dwordx4 v[84:87], v229, s[40:43], s12 offen
    v_mfma_f32_16x16x32_bf16 a[4:7], v[136:139], v[116:119], a[4:7]
    v_mfma_f32_16x16x32_bf16 a[24:27], v[136:139], v[120:123], a[24:27]
    buffer_load_dwordx4 v[88:91], v230, s[40:43], s12 offen
    v_mfma_f32_16x16x32_bf16 a[44:47], v[136:139], v[124:127], a[44:47]
    v_mfma_f32_16x16x32_bf16 a[64:67], v[136:139], v[128:131], a[64:67]
    buffer_load_dwordx4 v[92:95], v231, s[40:43], s12 offen
    v_mfma_f32_16x16x32_bf16 a[8:11], v[140:143], v[116:119], a[8:11]
    v_mfma_f32_16x16x32_bf16 a[28:31], v[140:143], v[120:123], a[28:31]
    buffer_load_dwordx4 v[96:99], v232, s[44:47], s13 offen offset:0
    v_mfma_f32_16x16x32_bf16 a[48:51], v[140:143], v[124:127], a[48:51]
    v_mfma_f32_16x16x32_bf16 a[68:71], v[140:143], v[128:131], a[68:71]
    buffer_load_dwordx4 v[100:103], v232, s[44:47], s13 offen offset:1024
    v_mfma_f32_16x16x32_bf16 a[12:15], v[144:147], v[116:119], a[12:15]
    v_mfma_f32_16x16x32_bf16 a[32:35], v[144:147], v[120:123], a[32:35]
    buffer_load_dwordx4 v[104:107], v232, s[44:47], s13 offen offset:2048
    v_mfma_f32_16x16x32_bf16 a[52:55], v[144:147], v[124:127], a[52:55]
    v_mfma_f32_16x16x32_bf16 a[72:75], v[144:147], v[128:131], a[72:75]
    buffer_load_dwordx4 v[108:111], v232, s[44:47], s13 offen offset:3072
    v_mfma_f32_16x16x32_bf16 a[16:19], v[148:151], v[116:119], a[16:19]
    v_mfma_f32_16x16x32_bf16 a[36:39], v[148:151], v[120:123], a[36:39]
    buffer_load_dwordx4 v[112:115], v233, s[44:47], s13 offen
    v_mfma_f32_16x16x32_bf16 a[56:59], v[148:151], v[124:127], a[56:59]
    v_mfma_f32_16x16x32_bf16 a[76:79], v[148:151], v[128:131], a[76:79]
    s_add_u32 s12, s12, 4096
    s_add_u32 s13, s13, 20480
    s_waitcnt vmcnt(18)
    v_mfma_f32_16x16x32_bf16 a[0:3], v[24:27], v[8:11], a[0:3]
    v_mfma_f32_16x16x32_bf16 a[20:23], v[24:27], v[12:15], a[20:23]
    buffer_load_dwordx4 v[116:119], v228, s[40:43], s12 offen
    v_mfma_f32_16x16x32_bf16 a[40:43], v[24:27], v[16:19], a[40:43]
    v_mfma_f32_16x16x32_bf16 a[60:63], v[24:27], v[20:23], a[60:63]
    buffer_load_dwordx4 v[120:123], v229, s[40:43], s12 offen
    v_mfma_f32_16x16x32_bf16 a[4:7], v[28:31], v[8:11], a[4:7]
    v_mfma_f32_16x16x32_bf16 a[24:27], v[28:31], v[12:15], a[24:27]
    buffer_load_dwordx4 v[124:127], v230, s[40:43], s12 offen
    v_mfma_f32_16x16x32_bf16 a[44:47], v[28:31], v[16:19], a[44:47]
    v_mfma_f32_16x16x32_bf16 a[64:67], v[28:31], v[20:23], a[64:67]
    buffer_load_dwordx4 v[128:131], v231, s[40:43], s12 offen
    v_mfma_f32_16x16x32_bf16 a[8:11], v[32:35], v[8:11], a[8:11]
    v_mfma_f32_16x16x32_bf16 a[28:31], v[32:35], v[12:15], a[28:31]
    buffer_load_dwordx4 v[132:135], v232, s[44:47], s13 offen offset:0
    v_mfma_f32_16x16x32_bf16 a[48:51], v[32:35], v[16:19], a[48:51]
    v_mfma_f32_16x16x32_bf16 a[68:71], v[32:35], v[20:23], a[68:71]
    buffer_load_dwordx4 v[136:139], v232, s[44:47], s13 offen offset:1024
    v_mfma_f32_16x16x32_bf16 a[12:15], v[36:39], v[8:11], a[12:15]
    v_mfma_f32_16x16x32_bf16 a[32:35], v[36:39], v[12:15], a[32:35]
    buffer_load_dwordx4 v[140:143], v232, s[44:47], s13 offen offset:2048
    v_mfma_f32_16x16x32_bf16 a[52:55], v[36:39], v[16:19], a[52:55]
    v_mfma_f32_16x16x32_bf16 a[72:75], v[36:39], v[20:23], a[72:75]
    buffer_load_dwordx4 v[144:147], v232, s[44:47], s13 offen offset:3072
    v_mfma_f32_16x16x32_bf16 a[16:19], v[40:43], v[8:11], a[16:19]
    v_mfma_f32_16x16x32_bf16 a[36:39], v[40:43], v[12:15], a[36:39]
    buffer_load_dwordx4 v[148:151], v233, s[44:47], s13 offen
    v_mfma_f32_16x16x32_bf16 a[56:59], v[40:43], v[16:19], a[56:59]
    v_mfma_f32_16x16x32_bf16 a[76:79], v[40:43], v[20:23], a[76:79]
    s_add_u32 s12, s12, 4096
    s_add_u32 s13, s13, 20480
    s_waitcnt vmcnt(18)
    v_mfma_f32_16x16x32_bf16 a[0:3], v[60:63], v[44:47], a[0:3]
    v_mfma_f32_16x16x32_bf16 a[20:23], v[60:63], v[48:51], a[20:23]
    buffer_load_dwordx4 v[8:11], v228, s[40:43], s12 offen
    v_mfma_f32_16x16x32_bf16 a[40:43], v[60:63], v[52:55], a[40:43]
    v_mfma_f32_16x16x32_bf16 a[60:63], v[60:63], v[56:59], a[60:63]
    buffer_load_dwordx4 v[12:15], v229, s[40:43], s12 offen
    v_mfma_f32_16x16x32_bf16 a[4:7], v[64:67], v[44:47], a[4:7]
    v_mfma_f32_16x16x32_bf16 a[24:27], v[64:67], v[48:51], a[24:27]
    buffer_load_dwordx4 v[16:19], v230, s[40:43], s12 offen
    v_mfma_f32_16x16x32_bf16 a[44:47], v[64:67], v[52:55], a[44:47]
    v_mfma_f32_16x16x32_bf16 a[64:67], v[64:67], v[56:59], a[64:67]
    buffer_load_dwordx4 v[20:23], v231, s[40:43], s12 offen
    v_mfma_f32_16x16x32_bf16 a[8:11], v[68:71], v[44:47], a[8:11]
    v_mfma_f32_16x16x32_bf16 a[28:31], v[68:71], v[48:51], a[28:31]
    buffer_load_dwordx4 v[24:27], v232, s[44:47], s13 offen offset:0
    v_mfma_f32_16x16x32_bf16 a[48:51], v[68:71], v[52:55], a[48:51]
    v_mfma_f32_16x16x32_bf16 a[68:71], v[68:71], v[56:59], a[68:71]
    buffer_load_dwordx4 v[28:31], v232, s[44:47], s13 offen offset:1024
    v_mfma_f32_16x16x32_bf16 a[12:15], v[72:75], v[44:47], a[12:15]
    v_mfma_f32_16x16x32_bf16 a[32:35], v[72:75], v[48:51], a[32:35]
    buffer_load_dwordx4 v[32:35], v232, s[44:47], s13 offen offset:2048
    v_mfma_f32_16x16x32_bf16 a[52:55], v[72:75], v[52:55], a[52:55]
    v_mfma_f32_16x16x32_bf16 a[72:75], v[72:75], v[56:59], a[72:75]
    buffer_load_dwordx4 v[36:39], v232, s[44:47], s13 offen offset:3072
    v_mfma_f32_16x16x32_bf16 a[16:19], v[76:79], v[44:47], a[16:19]
    v_mfma_f32_16x16x32_bf16 a[36:39], v[76:79], v[48:51], a[36:39]
    buffer_load_dwordx4 v[40:43], v233, s[44:47], s13 offen
    v_mfma_f32_16x16x32_bf16 a[56:59], v[76:79], v[52:55], a[56:59]
    v_mfma_f32_16x16x32_bf16 a[76:79], v[76:79], v[56:59], a[76:79]
    s_add_u32 s12, s12, 4096
    s_add_u32 s13, s13, 20480
    s_waitcnt vmcnt(18)
    v_mfma_f32_16x16x32_bf16 a[0:3], v[96:99], v[80:83], a[0:3]
    v_mfma_f32_16x16x32_bf16 a[20:23], v[96:99], v[84:87], a[20:23]
    v_mfma_f32_16x16x32_bf16 a[40:43], v[96:99], v[88:91], a[40:43]
    v_mfma_f32_16x16x32_bf16 a[60:63], v[96:99], v[92:95], a[60:63]
    v_mfma_f32_16x16x32_bf16 a[4:7], v[100:103], v[80:83], a[4:7]
    v_mfma_f32_16x16x32_bf16 a[24:27], v[100:103], v[84:87], a[24:27]
    v_mfma_f32_16x16x32_bf16 a[44:47], v[100:103], v[88:91], a[44:47]
    v_mfma_f32_16x16x32_bf16 a[64:67], v[100:103], v[92:95], a[64:67]
    v_mfma_f32_16x16x32_bf16 a[8:11], v[104:107], v[80:83], a[8:11]
    v_mfma_f32_16x16x32_bf16 a[28:31], v[104:107], v[84:87], a[28:31]
    v_mfma_f32_16x16x32_bf16 a[48:51], v[104:107], v[88:91], a[48:51]
    v_mfma_f32_16x16x32_bf16 a[68:71], v[104:107], v[92:95], a[68:71]
    v_mfma_f32_16x16x32_bf16 a[12:15], v[108:111], v[80:83], a[12:15]
    v_mfma_f32_16x16x32_bf16 a[32:35], v[108:111], v[84:87], a[32:35]
    v_mfma_f32_16x16x32_bf16 a[52:55], v[108:111], v[88:91], a[52:55]
    v_mfma_f32_16x16x32_bf16 a[72:75], v[108:111], v[92:95], a[72:75]
    v_mfma_f32_16x16x32_bf16 a[16:19], v[112:115], v[80:83], a[16:19]
    v_mfma_f32_16x16x32_bf16 a[36:39], v[112:115], v[84:87], a[36:39]
    v_mfma_f32_16x16x32_bf16 a[56:59], v[112:115], v[88:91], a[56:59]
    v_mfma_f32_16x16x32_bf16 a[76:79], v[112:115], v[92:95], a[76:79]
    s_waitcnt vmcnt(9)
    v_mfma_f32_16x16x32_bf16 a[0:3], v[132:135], v[116:119], a[0:3]
    v_mfma_f32_16x16x32_bf16 a[20:23], v[132:135], v[120:123], a[20:23]
    v_mfma_f32_16x16x32_bf16 a[40:43], v[132:135], v[124:127], a[40:43]
    v_mfma_f32_16x16x32_bf16 a[60:63], v[132:135], v[128:131], a[60:63]
    v_mfma_f32_16x16x32_bf16 a[4:7], v[136:139], v[116:119], a[4:7]
    v_mfma_f32_16x16x32_bf16 a[24:27], v[136:139], v[120:123], a[24:27]
    v_mfma_f32_16x16x32_bf16 a[44:47], v[136:139], v[124:127], a[44:47]
    v_mfma_f32_16x16x32_bf16 a[64:67], v[136:139], v[128:131], a[64:67]
    v_mfma_f32_16x16x32_bf16 a[8:11], v[140:143], v[116:119], a[8:11]
    v_mfma_f32_16x16x32_bf16 a[28:31], v[140:143], v[120:123], a[28:31]
    v_mfma_f32_16x16x32_bf16 a[48:51], v[140:143], v[124:127], a[48:51]
    v_mfma_f32_16x16x32_bf16 a[68:71], v[140:143], v[128:131], a[68:71]
    v_mfma_f32_16x16x32_bf16 a[12:15], v[144:147], v[116:119], a[12:15]
    v_mfma_f32_16x16x32_bf16 a[32:35], v[144:147], v[120:123], a[32:35]
    v_mfma_f32_16x16x32_bf16 a[52:55], v[144:147], v[124:127], a[52:55]
    v_mfma_f32_16x16x32_bf16 a[72:75], v[144:147], v[128:131], a[72:75]
    v_mfma_f32_16x16x32_bf16 a[16:19], v[148:151], v[116:119], a[16:19]
    v_mfma_f32_16x16x32_bf16 a[36:39], v[148:151], v[120:123], a[36:39]
    v_mfma_f32_16x16x32_bf16 a[56:59], v[148:151], v[124:127], a[56:59]
    v_mfma_f32_16x16x32_bf16 a[76:79], v[148:151], v[128:131], a[76:79]
    s_waitcnt vmcnt(0)
    v_mfma_f32_16x16x32_bf16 a[0:3], v[24:27], v[8:11], a[0:3]
    v_mfma_f32_16x16x32_bf16 a[20:23], v[24:27], v[12:15], a[20:23]
    v_mfma_f32_16x16x32_bf16 a[40:43], v[24:27], v[16:19], a[40:43]
    v_mfma_f32_16x16x32_bf16 a[60:63], v[24:27], v[20:23], a[60:63]
    v_mfma_f32_16x16x32_bf16 a[4:7], v[28:31], v[8:11], a[4:7]
    v_mfma_f32_16x16x32_bf16 a[24:27], v[28:31], v[12:15], a[24:27]
    v_mfma_f32_16x16x32_bf16 a[44:47], v[28:31], v[16:19], a[44:47]
    v_mfma_f32_16x16x32_bf16 a[64:67], v[28:31], v[20:23], a[64:67]
    v_mfma_f32_16x16x32_bf16 a[8:11], v[32:35], v[8:11], a[8:11]
    v_mfma_f32_16x16x32_bf16 a[28:31], v[32:35], v[12:15], a[28:31]
    v_mfma_f32_16x16x32_bf16 a[48:51], v[32:35], v[16:19], a[48:51]
    v_mfma_f32_16x16x32_bf16 a[68:71], v[32:35], v[20:23], a[68:71]
    v_mfma_f32_16x16x32_bf16 a[12:15], v[36:39], v[8:11], a[12:15]
    v_mfma_f32_16x16x32_bf16 a[32:35], v[36:39], v[12:15], a[32:35]
    v_mfma_f32_16x16x32_bf16 a[52:55], v[36:39], v[16:19], a[52:55]
    v_mfma_f32_16x16x32_bf16 a[72:75], v[36:39], v[20:23], a[72:75]
    v_mfma_f32_16x16x32_bf16 a[16:19], v[40:43], v[8:11], a[16:19]
    v_mfma_f32_16x16x32_bf16 a[36:39], v[40:43], v[12:15], a[36:39]
    v_mfma_f32_16x16x32_bf16 a[56:59], v[40:43], v[16:19], a[56:59]
    v_mfma_f32_16x16x32_bf16 a[76:79], v[40:43], v[20:23], a[76:79]
    s_mul_i32 s56, s8, 21504
    v_mul_u32_u24 v5, 336, v3
    v_lshl_add_u32 v5, v4, 4, v5
    v_add_u32 v5, s56, v5
    s_nop 7
    ds_write_b128 v5, a[0:3] offset:0
    ds_write_b128 v5, a[4:7] offset:64
    ds_write_b128 v5, a[8:11] offset:128
    ds_write_b128 v5, a[12:15] offset:192
    ds_write_b128 v5, a[16:19] offset:256
    ds_write_b128 v5, a[20:23] offset:5376
    ds_write_b128 v5, a[24:27] offset:5440
    ds_write_b128 v5, a[28:31] offset:5504
    ds_write_b128 v5, a[32:35] offset:5568
    ds_write_b128 v5, a[36:39] offset:5632
    ds_write_b128 v5, a[40:43] offset:10752
    ds_write_b128 v5, a[44:47] offset:10816
    ds_write_b128 v5, a[48:51] offset:10880
    ds_write_b128 v5, a[52:55] offset:10944
    ds_write_b128 v5, a[56:59] offset:11008
    ds_write_b128 v5, a[60:63] offset:16128
    ds_write_b128 v5, a[64:67] offset:16192
    ds_write_b128 v5, a[68:71] offset:16256
    ds_write_b128 v5, a[72:75] offset:16320
    ds_write_b128 v5, a[76:79] offset:16384
    s_waitcnt lgkmcnt(0)
    s_barrier
    v_add_u32 v5, 43008, v251
    v_add_u32 v6, 43008, v252
    v_add_u32 v7, 43008, v253
    ds_read_b128 v[8:11], v251 offset:0
    ds_read_b128 v[12:15], v251 offset:16
    ds_read_b128 v[16:19], v251 offset:21504
    ds_read_b128 v[20:23], v251 offset:21520
    ds_read_b128 v[24:27], v5 offset:0
    ds_read_b128 v[28:31], v5 offset:16
    ds_read_b128 v[32:35], v5 offset:21504
    ds_read_b128 v[36:39], v5 offset:21520
    ds_read_b128 v[40:43], v252 offset:0
    ds_read_b128 v[44:47], v252 offset:16
    ds_read_b128 v[48:51], v252 offset:21504
    ds_read_b128 v[52:55], v252 offset:21520
    ds_read_b128 v[56:59], v6 offset:0
    ds_read_b128 v[60:63], v6 offset:16
    ds_read_b128 v[64:67], v6 offset:21504
    ds_read_b128 v[68:71], v6 offset:21520
    ds_read_b128 v[72:75], v253 offset:0
    ds_read_b128 v[76:79], v253 offset:16
    ds_read_b128 v[80:83], v253 offset:21504
    ds_read_b128 v[84:87], v253 offset:21520
    ds_read_b128 v[88:91], v7 offset:0
    ds_read_b128 v[92:95], v7 offset:16
    ds_read_b128 v[96:99], v7 offset:21504
    ds_read_b128 v[100:103], v7 offset:21520
    s_waitcnt lgkmcnt(15)
    v_add_f32 v8, v8, v16
    v_add_f32 v24, v24, v32
    v_add_f32 v9, v9, v17
    v_add_f32 v25, v25, v33
    v_add_f32 v10, v10, v18
    v_add_f32 v26, v26, v34
    v_add_f32 v11, v11, v19
    v_add_f32 v27, v27, v35
    v_add_f32 v12, v12, v20
    v_add_f32 v28, v28, v36
    v_add_f32 v13, v13, v21
    v_add_f32 v29, v29, v37
    v_add_f32 v14, v14, v22
    v_add_f32 v30, v30, v38
    v_add_f32 v15, v15, v23
    v_add_f32 v31, v31, v39
    v_lshlrev_b32 v16, 16, v236
    v_and_b32 v17, 0xffff0000, v236
    v_lshlrev_b32 v18, 16, v237
    v_and_b32 v19, 0xffff0000, v237
    v_lshlrev_b32 v20, 16, v238
    v_and_b32 v21, 0xffff0000, v238
    v_lshlrev_b32 v22, 16, v239
    v_and_b32 v23, 0xffff0000, v239
    v_add_f32 v8, v8, v24
    v_add_f32 v9, v9, v25
    v_add_f32 v10, v10, v26
    v_add_f32 v11, v11, v27
    v_add_f32 v12, v12, v28
    v_add_f32 v13, v13, v29
    v_add_f32 v14, v14, v30
    v_add_f32 v15, v15, v31
    v_add_f32 v8, v8, v16
    v_add_f32 v9, v9, v17
    v_add_f32 v10, v10, v18
    v_add_f32 v11, v11, v19
    v_add_f32 v12, v12, v20
    v_add_f32 v13, v13, v21
    v_add_f32 v14, v14, v22
    v_add_f32 v15, v15, v23
    v_cvt_pk_bf16_f32 v236, v8, v9
    v_cvt_pk_bf16_f32 v237, v10, v11
    v_cvt_pk_bf16_f32 v238, v12, v13
    v_cvt_pk_bf16_f32 v239, v14, v15
    buffer_store_dwordx4 v[236:239], v248, s[52:55], 0 offen
    s_waitcnt lgkmcnt(8)
    v_add_f32 v40, v40, v48
    v_add_f32 v56, v56, v64
    v_add_f32 v41, v41, v49
    v_add_f32 v57, v57, v65
    v_add_f32 v42, v42, v50
    v_add_f32 v58, v58, v66
    v_add_f32 v43, v43, v51
    v_add_f32 v59, v59, v67
    v_add_f32 v44, v44, v52
    v_add_f32 v60, v60, v68
    v_add_f32 v45, v45, v53
    v_add_f32 v61, v61, v69
    v_add_f32 v46, v46, v54
    v_add_f32 v62, v62, v70
    v_add_f32 v47, v47, v55
    v_add_f32 v63, v63, v71
    v_lshlrev_b32 v48, 16, v240
    v_and_b32 v49, 0xffff0000, v240
    v_lshlrev_b32 v50, 16, v241
    v_and_b32 v51, 0xffff0000, v241
    v_lshlrev_b32 v52, 16, v242
    v_and_b32 v53, 0xffff0000, v242
    v_lshlrev_b32 v54, 16, v243
    v_and_b32 v55, 0xffff0000, v243
    v_add_f32 v40, v40, v56
    v_add_f32 v41, v41, v57
    v_add_f32 v42, v42, v58
    v_add_f32 v43, v43, v59
    v_add_f32 v44, v44, v60
    v_add_f32 v45, v45, v61
    v_add_f32 v46, v46, v62
    v_add_f32 v47, v47, v63
    v_add_f32 v40, v40, v48
    v_add_f32 v41, v41, v49
    v_add_f32 v42, v42, v50
    v_add_f32 v43, v43, v51
    v_add_f32 v44, v44, v52
    v_add_f32 v45, v45, v53
    v_add_f32 v46, v46, v54
    v_add_f32 v47, v47, v55
    v_cvt_pk_bf16_f32 v240, v40, v41
    v_cvt_pk_bf16_f32 v241, v42, v43
    v_cvt_pk_bf16_f32 v242, v44, v45
    v_cvt_pk_bf16_f32 v243, v46, v47
    buffer_store_dwordx4 v[240:243], v249, s[52:55], 0 offen
    s_waitcnt lgkmcnt(0)
    v_add_f32 v72, v72, v80
    v_add_f32 v88, v88, v96
    v_add_f32 v73, v73, v81
    v_add_f32 v89, v89, v97
    v_add_f32 v74, v74, v82
    v_add_f32 v90, v90, v98
    v_add_f32 v75, v75, v83
    v_add_f32 v91, v91, v99
    v_add_f32 v76, v76, v84
    v_add_f32 v92, v92, v100
    v_add_f32 v77, v77, v85
    v_add_f32 v93, v93, v101
    v_add_f32 v78, v78, v86
    v_add_f32 v94, v94, v102
    v_add_f32 v79, v79, v87
    v_add_f32 v95, v95, v103
    v_lshlrev_b32 v80, 16, v244
    v_and_b32 v81, 0xffff0000, v244
    v_lshlrev_b32 v82, 16, v245
    v_and_b32 v83, 0xffff0000, v245
    v_lshlrev_b32 v84, 16, v246
    v_and_b32 v85, 0xffff0000, v246
    v_lshlrev_b32 v86, 16, v247
    v_and_b32 v87, 0xffff0000, v247
    v_add_f32 v72, v72, v88
    v_add_f32 v73, v73, v89
    v_add_f32 v74, v74, v90
    v_add_f32 v75, v75, v91
    v_add_f32 v76, v76, v92
    v_add_f32 v77, v77, v93
    v_add_f32 v78, v78, v94
    v_add_f32 v79, v79, v95
    v_add_f32 v72, v72, v80
    v_add_f32 v73, v73, v81
    v_add_f32 v74, v74, v82
    v_add_f32 v75, v75, v83
    v_add_f32 v76, v76, v84
    v_add_f32 v77, v77, v85
    v_add_f32 v78, v78, v86
    v_add_f32 v79, v79, v87
    v_cvt_pk_bf16_f32 v244, v72, v73
    v_cvt_pk_bf16_f32 v245, v74, v75
    v_cvt_pk_bf16_f32 v246, v76, v77
    v_cvt_pk_bf16_f32 v247, v78, v79
    buffer_store_dwordx4 v[244:247], v250, s[52:55], 0 offen
k2_done:
    s_endpgm
.section .rodata,"a"
.p2align 6
.amdhsa_kernel gemm2_kernel
  .amdhsa_next_free_vgpr 336
  .amdhsa_next_free_sgpr 64
  .amdhsa_accum_offset 256
  .amdhsa_group_segment_fixed_size 0
  .amdhsa_kernarg_size 80
  .amdhsa_user_sgpr_count 2
  .amdhsa_user_sgpr_kernarg_segment_ptr 1
  .amdhsa_system_sgpr_workgroup_id_x 1
.end_amdhsa_kernel
.text
```
